```python
import torch

def _softmax(x, axis=-1):
    return torch.softmax(x, dim=axis)
def _gelu(x):
    return torch.nn.functional.gelu(x, approximate="tanh")
def _silu(x):
    return torch.nn.functional.silu(x)
def _sigmoid(x):
    return torch.sigmoid(x)
def _layernorm(x, axis=-1, eps=1e-5):
    m = x.mean(dim=axis, keepdim=True)
    v = x.var(dim=axis, keepdim=True, unbiased=False)
    return (x - m) / torch.sqrt(v + eps)
def _scatter_add(tgt, idx, src, axis=0):
    return tgt.clone().index_add_(axis, idx, src)
def _segment_sum(src, seg, n):
    out = torch.zeros((n,) + src.shape[1:], dtype=src.dtype)
    return out.index_add_(0, seg, src)
def _pad(x, pw):
    flat = tuple(v for pair in reversed(pw) for v in pair)
    return torch.nn.functional.pad(x, flat)

kernel_name = 'concat_heads__sliding_local_dilated__spectral_fnet__prompt'

def setup_inputs():

    _w = (lambda a: (lambda t: t.to(torch.bfloat16) if t.is_floating_point() else t)(torch.as_tensor(a)))
    def _A_setup():
        B, S, D = 1, 2048, 1024
        return {
            "x": _w((lambda *s: torch.randn(*s, dtype=torch.bfloat16) * 0.2)(B, S, D)),
            "wqkv": _w((lambda *s: torch.randn(*s, dtype=torch.bfloat16) * 0.8)(D, 3 * D)),
            "wo": _w((lambda *s: torch.randn(*s, dtype=torch.bfloat16) * 0.2)(D, D)),
        }
    _A_in = _A_setup()

    def _B_setup():
        B, S, D = 1, 2048, 1024
        ns = torch.arange(S)[:, None] * torch.arange(S)[None, :]
        nd = torch.arange(D)[:, None] * torch.arange(D)[None, :]
        Ws_re = torch.cos(-2.0 * torch.pi * ns / S).to(float)
        Ws_im = torch.sin(-2.0 * torch.pi * ns / S).to(float)
        Wd_re = torch.cos(-2.0 * torch.pi * nd / D).to(float)
        Wd_im = torch.sin(-2.0 * torch.pi * nd / D).to(float)
        return {
            "x": _w((lambda *s: torch.randn(*s, dtype=torch.bfloat16) * 0.05)(B, S, D)),
            "dft_seq_re": _w(Ws_re),
            "dft_seq_im": _w(Ws_im),
            "dft_hid_re": _w(Wd_re),
            "dft_hid_im": _w(Wd_im),
        }
    _B_in = _B_setup()

    return {
        "A_x": _A_in["x"],
        "A_wqkv": _A_in["wqkv"],
        "A_wo": _A_in["wo"],
        "B_x": _B_in["x"],
        "B_dft_seq_re": _B_in["dft_seq_re"],
        "B_dft_seq_im": _B_in["dft_seq_im"],
        "B_dft_hid_re": _B_in["dft_hid_re"],
        "B_dft_hid_im": _B_in["dft_hid_im"],
    }

def reference(A_x, A_wqkv, A_wo, B_x, B_dft_seq_re, B_dft_seq_im, B_dft_hid_re, B_dft_hid_im):
    def _A_ref(x, wqkv, wo):
        B, S, D = x.shape
        H = 32; Dh = D // H
        W, dil = 8, 2
        qkv = (lambda x, *d: x.permute(*d))((x @ wqkv).reshape(B, S, 3, H, Dh), 2, 0, 3, 1, 4)
        q, k, v = qkv[0], qkv[1], qkv[2]
        scale = Dh ** -0.5
        pos = torch.arange(S)
        off = torch.arange(W) * dil
        idx = pos[:, None] - off[None, :]
        mask = idx >= 0
        idx_c = torch.where(mask, idx, 0).reshape(-1)
        kg = k[:, :, idx_c, :].reshape(B, H, S, W, Dh)
        vg = v[:, :, idx_c, :].reshape(B, H, S, W, Dh)
        logits = torch.einsum("bhsd,bhswd->bhsw", q, kg) * scale
        logits = torch.where(mask[None, None, :, :], logits, -1e9)
        attn = _softmax(logits, axis=-1)
        o = torch.einsum("bhsw,bhswd->bhsd", attn, vg)
        return (lambda x, *d: x.permute(*d))(o, 0, 2, 1, 3).reshape(B, S, D) @ wo

    def _B_ref(x, dft_seq_re, dft_seq_im, dft_hid_re, dft_hid_im):
        a = torch.einsum("bsd,ed->bse", x, dft_hid_re)
        b = torch.einsum("bsd,ed->bse", x, dft_hid_im)
        y = torch.einsum("ts,bse->bte", dft_seq_re, a) - torch.einsum("ts,bse->bte", dft_seq_im, b)
        return y

    a = _A_ref(A_x, A_wqkv, A_wo)
    b = _B_ref(B_x, B_dft_seq_re, B_dft_seq_im, B_dft_hid_re, B_dft_hid_im)
    return torch.concatenate([a, b], axis=-1)
```

```asm
; @launch grid=(256,1,1) block=(512,1,1) lds=163840
.amdgcn_target "amdgcn-amd-amdhsa--gfx950"
.text
.globl concat_heads__sliding_local_dilated__spectral_fnet__prompt_kernel
.p2align 8
.type concat_heads__sliding_local_dilated__spectral_fnet__prompt_kernel,@function
concat_heads__sliding_local_dilated__spectral_fnet__prompt_kernel:
    s_cmp_ge_u32 s2, 256
    s_cbranch_scc1 L_end
    s_load_dwordx8 s[4:11], s[0:1], 0
    s_load_dwordx4 s[20:23], s[0:1], 64
    s_load_dwordx2 s[24:25], s[0:1], 80
    s_getpc_b64 s[86:87]
L_pc:
    s_sub_u32 s86, s86, L_pc-concat_heads__sliding_local_dilated__spectral_fnet__prompt_kernel
    s_subb_u32 s87, s87, 0
    s_and_b32 s81, s2, 0xf8
    v_lshrrev_b32 v4, 6, v0
    v_add_u32 v4, s81, v4
    v_lshlrev_b32 v4, 7, v4
    v_min_u32 v4, L_end-concat_heads__sliding_local_dilated__spectral_fnet__prompt_kernel, v4
    global_load_dword v250, v4, s[86:87]
    v_lshrrev_b32 v4, 6, v0
    v_and_b32 v1, 63, v0
    v_readfirstlane_b32 s72, v4
    v_and_b32 v2, 15, v0
    v_lshrrev_b32 v3, 4, v1
    s_and_b32 s81, s2, 7
    s_lshr_b32 s82, s2, 3
    s_and_b32 s83, s81, 1
    s_lshl_b32 s85, s83, 3
    s_and_b32 s84, s82, 7
    s_add_u32 s73, s85, s84
    s_lshr_b32 s86, s81, 1
    s_lshl_b32 s85, s86, 2
    s_lshr_b32 s84, s82, 3
    s_add_u32 s74, s85, s84
    s_mov_b32 s79, 0
    s_lshl_b32 s83, s81, 1
    s_lshr_b32 s84, s82, 4
    s_add_u32 s16, s83, s84
    s_and_b32 s17, s82, 15
    s_lshr_b32 s83, s81, 1
    s_lshl_b32 s83, s83, 2
    s_lshr_b32 s84, s82, 3
    s_add_u32 s75, s83, s84
    s_and_b32 s83, s81, 1
    s_lshl_b32 s83, s83, 3
    s_and_b32 s85, s82, 7
    s_add_u32 s76, s83, s85
    s_lshl_b32 s85, s85, 1
    s_lshl_b32 s84, s84, 2
    s_add_u32 s85, s85, s84
    s_and_b32 s80, s85, 15
    s_lshl_b32 s83, s81, 4
    s_lshr_b32 s84, s82, 1
    s_add_u32 s77, s83, s84
    s_and_b32 s78, s82, 1
    s_mov_b32 s30, 0x400000
    s_mov_b32 s31, 0x20000
    s_mov_b32 s34, 0x600000
    s_mov_b32 s35, 0x20000
    s_mov_b32 s38, 0x200000
    s_mov_b32 s39, 0x20000
    s_mov_b32 s42, 0x400000
    s_mov_b32 s43, 0x20000
    s_mov_b32 s62, 0x800000
    s_mov_b32 s63, 0x20000
    s_mov_b32 s66, 0x10000000
    s_mov_b32 s67, 0x20000
    s_mov_b32 s70, 0x100
    s_mov_b32 s71, 0x20000
    s_waitcnt lgkmcnt(0)
    s_mov_b64 s[28:29], s[4:5]
    s_mov_b64 s[32:33], s[6:7]
    s_mov_b64 s[36:37], s[8:9]
    s_mov_b64 s[40:41], s[10:11]
    s_mov_b64 s[60:61], s[20:21]
    s_mov_b64 s[64:65], s[24:25]
    s_mov_b64 s[68:69], s[22:23]
    s_cmp_ge_u32 s72, 6
    s_cbranch_scc1 L_pf
    s_cmp_ge_u32 s72, 4
    s_cbranch_scc1 L_ld
    v_and_b32 v4, 1, v3
    v_lshlrev_b32 v4, 1, v4
    v_and_b32 v5, 3, v1
    v_xor_b32 v4, v4, v5
    v_lshlrev_b32 v4, 4, v4
    v_lshrrev_b32 v5, 2, v1
    v_lshl_add_u32 v4, v5, 6, v4
    s_lshl_b32 s81, s72, 9
    s_add_u32 s81, s81, s77
    s_lshl_b32 s81, s81, 11
    s_lshl_b32 s82, s72, 13
    s_add_u32 m0, s82, 131072
    s_add_u32 s83, s81, 0
    buffer_load_dwordx4 v4, s[40:43], s83 offen nt lds
    buffer_load_dwordx4 v4, s[40:43], s83 offen offset:1024 nt lds
    s_add_u32 m0, s82, 133120
    s_add_u32 s83, s81, 262144
    buffer_load_dwordx4 v4, s[40:43], s83 offen nt lds
    buffer_load_dwordx4 v4, s[40:43], s83 offen offset:1024 nt lds
    s_add_u32 m0, s82, 135168
    s_add_u32 s83, s81, 524288
    buffer_load_dwordx4 v4, s[40:43], s83 offen nt lds
    buffer_load_dwordx4 v4, s[40:43], s83 offen offset:1024 nt lds
    s_add_u32 m0, s82, 137216
    s_add_u32 s83, s81, 786432
    buffer_load_dwordx4 v4, s[40:43], s83 offen nt lds
    buffer_load_dwordx4 v4, s[40:43], s83 offen offset:1024 nt lds
    v_mov_b32 v247, 129792
    v_mov_b32 v5, 0
    ds_write_b32 v247, v5
    s_waitcnt lgkmcnt(0)
    s_barrier
    v_cvt_f32_u32 v4, v2
    v_mul_f32 v14, 0x3d000000, v4
    v_lshlrev_b32 v5, 2, v3
    v_cvt_f32_u32 v5, v5
    v_mul_f32 v15, v5, v14
    v_mov_b32 v8, v15
    v_add_f32 v9, v8, v14
    v_cos_f32 v10, v8
    v_sin_f32 v12, v8
    v_cos_f32 v11, v9
    v_sin_f32 v13, v9
    v_cvt_pk_bf16_f32 v152, v10, v11
    v_cvt_pk_bf16_f32 v156, v12, v13
    v_add_f32 v8, v9, v14
    v_add_f32 v9, v8, v14
    v_cos_f32 v10, v8
    v_sin_f32 v12, v8
    v_cos_f32 v11, v9
    v_sin_f32 v13, v9
    v_cvt_pk_bf16_f32 v153, v10, v11
    v_cvt_pk_bf16_f32 v157, v12, v13
    v_and_b32 v7, 1, v2
    v_mul_u32_u24 v7, 0x8000, v7
    v_lshl_or_b32 v7, v7, 16, v7
    v_xor_b32 v154, v7, v152
    v_xor_b32 v158, v7, v156
    v_xor_b32 v155, v7, v153
    v_xor_b32 v159, v7, v157
    s_lshl_b32 s87, s78, 31
    s_xor_b32 s88, s87, 0x80008000
    v_xor_b32 v160, 0x80008000, v156
    v_xor_b32 v144, s87, v152
    v_xor_b32 v148, s88, v156
    v_xor_b32 v161, 0x80008000, v157
    v_xor_b32 v145, s87, v153
    v_xor_b32 v149, s88, v157
    v_xor_b32 v162, 0x80008000, v158
    v_xor_b32 v146, s87, v154
    v_xor_b32 v150, s88, v158
    v_xor_b32 v163, 0x80008000, v159
    v_xor_b32 v147, s87, v155
    v_xor_b32 v151, s88, v159
    s_mul_i32 s87, s78, 0x41800000
    v_add_f32 v4, s87, v4
    v_mul_f32 v4, 0x3a800000, v4
    v_mul_f32 v6, v5, v4
    s_mov_b32 s88, 0x41500000
    v_cos_f32 v96, v6
    v_sin_f32 v104, v6
    v_add_f32 v6, v6, v4
    v_cos_f32 v97, v6
    v_sin_f32 v105, v6
    v_add_f32 v6, v6, v4
    v_cos_f32 v98, v6
    v_sin_f32 v106, v6
    v_add_f32 v6, v6, v4
    v_cos_f32 v99, v6
    v_sin_f32 v107, v6
    v_fma_f32 v6, v4, s88, v6
    v_cos_f32 v100, v6
    v_sin_f32 v108, v6
    v_add_f32 v6, v6, v4
    v_cos_f32 v101, v6
    v_sin_f32 v109, v6
    v_add_f32 v6, v6, v4
    v_cos_f32 v102, v6
    v_sin_f32 v110, v6
    v_add_f32 v6, v6, v4
    v_cos_f32 v103, v6
    v_sin_f32 v111, v6
    v_cvt_f32_u32 v14, v2
    v_mul_f32 v14, 0x3d800000, v14
    v_lshlrev_b32 v15, 2, v3
    v_cvt_f32_u32 v15, v15
    v_mul_f32 v15, v15, v14
    v_mov_b32 v8, v15
    v_add_f32 v9, v8, v14
    v_cos_f32 v10, v8
    v_sin_f32 v12, v8
    v_cos_f32 v11, v9
    v_sin_f32 v13, v9
    v_cvt_pk_bf16_f32 v164, v10, v11
    v_cvt_pk_bf16_f32 v166, v12, v13
    v_add_f32 v8, v9, v14
    v_add_f32 v9, v8, v14
    v_cos_f32 v10, v8
    v_sin_f32 v12, v8
    v_cos_f32 v11, v9
    v_sin_f32 v13, v9
    v_cvt_pk_bf16_f32 v165, v10, v11
    v_cvt_pk_bf16_f32 v167, v12, v13
    v_mov_b32 v168, v166
    v_mov_b32 v169, v167
    v_xor_b32 v170, 0x80008000, v164
    v_xor_b32 v171, 0x80008000, v165
    s_lshl_b32 s83, s72, 13
    s_add_u32 s83, s83, 131072
    v_lshrrev_b32 v4, 2, v2
    v_lshl_add_u32 v4, v3, 2, v4
    v_lshlrev_b32 v4, 6, v4
    v_and_b32 v5, 3, v2
    v_lshl_add_u32 v4, v5, 3, v4
    v_and_b32 v6, 1, v3
    v_lshl_add_u32 v4, v6, 5, v4
    v_add_u32 v236, s83, v4
    v_xor_b32 v4, 32, v4
    v_add_u32 v237, s83, v4
    v_lshrrev_b32 v4, 1, v2
    v_xor_b32 v4, v4, v3
    v_lshlrev_b32 v4, 3, v4
    v_lshl_add_u32 v4, v2, 6, v4
    v_xor_b32 v5, 32, v4
    s_and_b32 s84, s72, 1
    s_lshl_b32 s84, s84, 7
    v_add_u32 v238, s84, v4
    v_and_b32 v238, 1023, v238
    v_add_u32 v238, s83, v238
    v_add_u32 v239, s84, v5
    v_and_b32 v239, 1023, v239
    v_add_u32 v239, s83, v239
    s_add_u32 s84, s84, 32
    v_add_u32 v240, s84, v4
    v_and_b32 v240, 1023, v240
    v_add_u32 v240, s83, v240
    v_add_u32 v241, s84, v5
    v_and_b32 v241, 1023, v241
    v_add_u32 v241, s83, v241
    s_add_u32 s84, s84, 32
    v_add_u32 v242, s84, v4
    v_and_b32 v242, 1023, v242
    v_add_u32 v242, s83, v242
    v_add_u32 v243, s84, v5
    v_and_b32 v243, 1023, v243
    v_add_u32 v243, s83, v243
    s_add_u32 s84, s84, 32
    v_add_u32 v244, s84, v4
    v_and_b32 v244, 1023, v244
    v_add_u32 v244, s83, v244
    v_add_u32 v245, s84, v5
    v_and_b32 v245, 1023, v245
    v_add_u32 v245, s83, v245
    s_lshl_b32 s85, s72, 7
    s_add_u32 s85, s85, 129024
    v_lshl_add_u32 v246, v3, 3, s85
    v_lshlrev_b32 v15, 3, v3
    v_add_u32 v15, 129536, v15
    v_mov_b32 v172, 0xbf803f80
    v_mov_b32 v173, 0xbf803f80
    v_mov_b32 v174, 0xbf803f80
    v_mov_b32 v175, 0xbf803f80
    v_mov_b32 v176, 0
    v_mov_b32 v177, 0
    ds_write_b64 v15, v[176:177]
    v_lshrrev_b32 v7, 2, v2
    v_lshl_add_u32 v4, v3, 2, v7
    v_and_b32 v6, 7, v4
    v_lshlrev_b32 v6, 5, v6
    v_and_b32 v5, 3, v2
    v_lshlrev_b32 v201, 3, v5
    v_lshl_add_u32 v200, v4, 5, v201
    v_add_u32 v200, 129024, v200
    v_add_u32 v201, 129536, v201
    v_lshlrev_b32 v4, 11, v4
    v_add_u32 v4, 131072, v4
    s_lshl_b32 s84, s72, 8
    v_add_u32 v6, s84, v6
    s_lshl_b32 s84, s72, 1
    v_xor_b32 v5, s84, v5
    v_lshlrev_b32 v5, 3, v5
    v_xor_b32 v7, 0, v5
    v_add_u32 v7, v7, v6
    v_add_u32 v7, 0, v7
    v_and_b32 v7, 1023, v7
    v_add_u32 v192, v4, v7
    v_xor_b32 v7, 32, v5
    v_add_u32 v7, v7, v6
    v_add_u32 v7, 0, v7
    v_and_b32 v7, 1023, v7
    v_add_u32 v193, v4, v7
    v_xor_b32 v7, 0, v5
    v_add_u32 v7, v7, v6
    v_add_u32 v7, 64, v7
    v_and_b32 v7, 1023, v7
    v_add_u32 v194, v4, v7
    v_xor_b32 v7, 32, v5
    v_add_u32 v7, v7, v6
    v_add_u32 v7, 64, v7
    v_and_b32 v7, 1023, v7
    v_add_u32 v195, v4, v7
    v_xor_b32 v7, 8, v5
    v_add_u32 v7, v7, v6
    v_add_u32 v7, 128, v7
    v_and_b32 v7, 1023, v7
    v_add_u32 v196, v4, v7
    v_xor_b32 v7, 40, v5
    v_add_u32 v7, v7, v6
    v_add_u32 v7, 128, v7
    v_and_b32 v7, 1023, v7
    v_add_u32 v197, v4, v7
    v_xor_b32 v7, 8, v5
    v_add_u32 v7, v7, v6
    v_add_u32 v7, 192, v7
    v_and_b32 v7, 1023, v7
    v_add_u32 v198, v4, v7
    v_xor_b32 v7, 40, v5
    v_add_u32 v7, v7, v6
    v_add_u32 v7, 192, v7
    v_and_b32 v7, 1023, v7
    v_add_u32 v199, v4, v7
    s_lshl_b32 s85, s72, 13
    s_add_u32 s85, s85, 132096
    v_lshl_add_u32 v202, v1, 4, s85
    v_lshlrev_b32 v203, 4, v1
    v_add_u32 v203, 130048, v203
    s_waitcnt vmcnt(6)
    ds_read_b64_tr_b16 v[16:17], v236 offset:0
    ds_read_b64_tr_b16 v[18:19], v236 offset:1024
    ds_read_b64_tr_b16 v[20:21], v237 offset:0
    ds_read_b64_tr_b16 v[22:23], v237 offset:1024
    s_waitcnt vmcnt(4)
    ds_read_b64_tr_b16 v[24:25], v236 offset:2048
    ds_read_b64_tr_b16 v[26:27], v236 offset:3072
    ds_read_b64_tr_b16 v[28:29], v237 offset:2048
    ds_read_b64_tr_b16 v[30:31], v237 offset:3072
    s_waitcnt vmcnt(2)
    ds_read_b64_tr_b16 v[204:205], v236 offset:4096
    ds_read_b64_tr_b16 v[206:207], v236 offset:5120
    ds_read_b64_tr_b16 v[208:209], v237 offset:4096
    ds_read_b64_tr_b16 v[210:211], v237 offset:5120
    s_waitcnt vmcnt(0)
    ds_read_b64_tr_b16 v[212:213], v236 offset:6144
    ds_read_b64_tr_b16 v[214:215], v236 offset:7168
    ds_read_b64_tr_b16 v[216:217], v237 offset:6144
    ds_read_b64_tr_b16 v[218:219], v237 offset:7168
    s_waitcnt lgkmcnt(12)
    v_mfma_f32_16x16x32_bf16 v[32:35], v[16:19], v[144:147], 0
    v_mfma_f32_16x16x32_bf16 v[40:43], v[16:19], v[148:151], 0
    v_mfma_f32_16x16x32_bf16 v[36:39], v[20:23], v[144:147], 0
    v_mfma_f32_16x16x32_bf16 v[44:47], v[20:23], v[148:151], 0
    s_waitcnt lgkmcnt(8)
    v_mfma_f32_16x16x32_bf16 v[48:51], v[24:27], v[144:147], 0
    v_mfma_f32_16x16x32_bf16 v[56:59], v[24:27], v[148:151], 0
    v_mfma_f32_16x16x32_bf16 v[52:55], v[28:31], v[144:147], 0
    v_mfma_f32_16x16x32_bf16 v[60:63], v[28:31], v[148:151], 0
    s_waitcnt lgkmcnt(0)
    v_pk_mul_f32 v[64:65], v[32:33], v[96:97]
    v_pk_mul_f32 v[72:73], v[40:41], v[96:97]
    v_pk_mul_f32 v[66:67], v[34:35], v[98:99]
    v_pk_mul_f32 v[74:75], v[42:43], v[98:99]
    v_pk_mul_f32 v[68:69], v[36:37], v[100:101]
    v_pk_mul_f32 v[76:77], v[44:45], v[100:101]
    v_pk_mul_f32 v[70:71], v[38:39], v[102:103]
    v_pk_mul_f32 v[78:79], v[46:47], v[102:103]
    v_pk_fma_f32 v[64:65], v[40:41], v[104:105], v[64:65]
    v_pk_fma_f32 v[72:73], v[32:33], v[104:105], v[72:73] neg_lo:[1,0,0] neg_hi:[1,0,0]
    v_pk_fma_f32 v[66:67], v[42:43], v[106:107], v[66:67]
    v_pk_fma_f32 v[74:75], v[34:35], v[106:107], v[74:75] neg_lo:[1,0,0] neg_hi:[1,0,0]
    v_pk_fma_f32 v[68:69], v[44:45], v[108:109], v[68:69]
    v_pk_fma_f32 v[76:77], v[36:37], v[108:109], v[76:77] neg_lo:[1,0,0] neg_hi:[1,0,0]
    v_pk_fma_f32 v[70:71], v[46:47], v[110:111], v[70:71]
    v_pk_fma_f32 v[78:79], v[38:39], v[110:111], v[78:79] neg_lo:[1,0,0] neg_hi:[1,0,0]
    v_cvt_pk_bf16_f32 v112, v64, v65
    v_cvt_pk_bf16_f32 v113, v66, v67
    v_cvt_pk_bf16_f32 v114, v68, v69
    v_cvt_pk_bf16_f32 v115, v70, v71
    v_cvt_pk_bf16_f32 v116, v72, v73
    v_cvt_pk_bf16_f32 v117, v74, v75
    v_cvt_pk_bf16_f32 v118, v76, v77
    v_cvt_pk_bf16_f32 v119, v78, v79
    v_mfma_f32_16x16x32_bf16 v[32:35], v[204:207], v[144:147], 0
    v_mfma_f32_16x16x32_bf16 v[40:43], v[204:207], v[148:151], 0
    v_mfma_f32_16x16x32_bf16 v[36:39], v[208:211], v[144:147], 0
    v_mfma_f32_16x16x32_bf16 v[44:47], v[208:211], v[148:151], 0
    v_mfma_f32_16x16x32_bf16 v[128:131], v[112:115], v[152:155], 0
    v_mfma_f32_16x16x32_bf16 v[80:83], v[112:115], v[172:175], 0
    v_mfma_f32_16x16x32_bf16 v[132:135], v[116:119], v[152:155], 0
    v_mfma_f32_16x16x32_bf16 v[128:131], v[116:119], v[156:159], v[128:131]
    v_mfma_f32_16x16x32_bf16 v[132:135], v[112:115], v[160:163], v[132:135]
    v_pk_mul_f32 v[64:65], v[48:49], v[96:97]
    v_pk_mul_f32 v[72:73], v[56:57], v[96:97]
    v_pk_mul_f32 v[66:67], v[50:51], v[98:99]
    v_pk_mul_f32 v[74:75], v[58:59], v[98:99]
    v_pk_mul_f32 v[68:69], v[52:53], v[100:101]
    v_pk_mul_f32 v[76:77], v[60:61], v[100:101]
    v_pk_mul_f32 v[70:71], v[54:55], v[102:103]
    v_pk_mul_f32 v[78:79], v[62:63], v[102:103]
    v_pk_fma_f32 v[64:65], v[56:57], v[104:105], v[64:65]
    v_pk_fma_f32 v[72:73], v[48:49], v[104:105], v[72:73] neg_lo:[1,0,0] neg_hi:[1,0,0]
    v_pk_fma_f32 v[66:67], v[58:59], v[106:107], v[66:67]
    v_pk_fma_f32 v[74:75], v[50:51], v[106:107], v[74:75] neg_lo:[1,0,0] neg_hi:[1,0,0]
    v_pk_fma_f32 v[68:69], v[60:61], v[108:109], v[68:69]
    v_pk_fma_f32 v[76:77], v[52:53], v[108:109], v[76:77] neg_lo:[1,0,0] neg_hi:[1,0,0]
    v_pk_fma_f32 v[70:71], v[62:63], v[110:111], v[70:71]
    v_pk_fma_f32 v[78:79], v[54:55], v[110:111], v[78:79] neg_lo:[1,0,0] neg_hi:[1,0,0]
    v_cvt_pk_bf16_f32 v120, v64, v65
    v_cvt_pk_bf16_f32 v121, v66, v67
    v_cvt_pk_bf16_f32 v122, v68, v69
    v_cvt_pk_bf16_f32 v123, v70, v71
    v_cvt_pk_bf16_f32 v124, v72, v73
    v_cvt_pk_bf16_f32 v125, v74, v75
    v_cvt_pk_bf16_f32 v126, v76, v77
    v_cvt_pk_bf16_f32 v127, v78, v79
    v_mfma_f32_16x16x32_bf16 v[48:51], v[212:215], v[144:147], 0
    v_mfma_f32_16x16x32_bf16 v[56:59], v[212:215], v[148:151], 0
    v_mfma_f32_16x16x32_bf16 v[52:55], v[216:219], v[144:147], 0
    v_mfma_f32_16x16x32_bf16 v[60:63], v[216:219], v[148:151], 0
    v_mfma_f32_16x16x32_bf16 v[136:139], v[120:123], v[152:155], 0
    v_mfma_f32_16x16x32_bf16 v[84:87], v[120:123], v[172:175], 0
    v_mfma_f32_16x16x32_bf16 v[140:143], v[124:127], v[152:155], 0
    v_mfma_f32_16x16x32_bf16 v[136:139], v[124:127], v[156:159], v[136:139]
    v_mfma_f32_16x16x32_bf16 v[140:143], v[120:123], v[160:163], v[140:143]
    v_cvt_pk_bf16_f32 v80, v80, v81
    v_cvt_pk_bf16_f32 v81, v82, v83
    ds_write_b64 v246, v[80:81] offset:0
    v_cvt_pk_bf16_f32 v88, v128, v129
    v_cvt_pk_bf16_f32 v89, v130, v131
    v_cvt_pk_bf16_f32 v90, v132, v133
    v_cvt_pk_bf16_f32 v91, v134, v135
    ds_write_b64 v238, v[88:89] offset:0
    ds_write_b64 v239, v[90:91] offset:0
    v_pk_mul_f32 v[64:65], v[32:33], v[96:97]
    v_pk_mul_f32 v[72:73], v[40:41], v[96:97]
    v_pk_mul_f32 v[66:67], v[34:35], v[98:99]
    v_pk_mul_f32 v[74:75], v[42:43], v[98:99]
    v_pk_mul_f32 v[68:69], v[36:37], v[100:101]
    v_pk_mul_f32 v[76:77], v[44:45], v[100:101]
    v_pk_mul_f32 v[70:71], v[38:39], v[102:103]
    v_pk_mul_f32 v[78:79], v[46:47], v[102:103]
    v_pk_fma_f32 v[64:65], v[40:41], v[104:105], v[64:65]
    v_pk_fma_f32 v[72:73], v[32:33], v[104:105], v[72:73] neg_lo:[1,0,0] neg_hi:[1,0,0]
    v_pk_fma_f32 v[66:67], v[42:43], v[106:107], v[66:67]
    v_pk_fma_f32 v[74:75], v[34:35], v[106:107], v[74:75] neg_lo:[1,0,0] neg_hi:[1,0,0]
    v_pk_fma_f32 v[68:69], v[44:45], v[108:109], v[68:69]
    v_pk_fma_f32 v[76:77], v[36:37], v[108:109], v[76:77] neg_lo:[1,0,0] neg_hi:[1,0,0]
    v_pk_fma_f32 v[70:71], v[46:47], v[110:111], v[70:71]
    v_pk_fma_f32 v[78:79], v[38:39], v[110:111], v[78:79] neg_lo:[1,0,0] neg_hi:[1,0,0]
    v_cvt_pk_bf16_f32 v112, v64, v65
    v_cvt_pk_bf16_f32 v113, v66, v67
    v_cvt_pk_bf16_f32 v114, v68, v69
    v_cvt_pk_bf16_f32 v115, v70, v71
    v_cvt_pk_bf16_f32 v116, v72, v73
    v_cvt_pk_bf16_f32 v117, v74, v75
    v_cvt_pk_bf16_f32 v118, v76, v77
    v_cvt_pk_bf16_f32 v119, v78, v79
    v_mfma_f32_16x16x32_bf16 v[128:131], v[112:115], v[152:155], 0
    v_mfma_f32_16x16x32_bf16 v[80:83], v[112:115], v[172:175], 0
    v_mfma_f32_16x16x32_bf16 v[132:135], v[116:119], v[152:155], 0
    v_mfma_f32_16x16x32_bf16 v[128:131], v[116:119], v[156:159], v[128:131]
    v_mfma_f32_16x16x32_bf16 v[132:135], v[112:115], v[160:163], v[132:135]
    v_cvt_pk_bf16_f32 v84, v84, v85
    v_cvt_pk_bf16_f32 v85, v86, v87
    ds_write_b64 v246, v[84:85] offset:32
    v_cvt_pk_bf16_f32 v92, v136, v137
    v_cvt_pk_bf16_f32 v93, v138, v139
    v_cvt_pk_bf16_f32 v94, v140, v141
    v_cvt_pk_bf16_f32 v95, v142, v143
    ds_write_b64 v240, v[92:93] offset:2048
    ds_write_b64 v241, v[94:95] offset:2048
    v_pk_mul_f32 v[64:65], v[48:49], v[96:97]
    v_pk_mul_f32 v[72:73], v[56:57], v[96:97]
    v_pk_mul_f32 v[66:67], v[50:51], v[98:99]
    v_pk_mul_f32 v[74:75], v[58:59], v[98:99]
    v_pk_mul_f32 v[68:69], v[52:53], v[100:101]
    v_pk_mul_f32 v[76:77], v[60:61], v[100:101]
    v_pk_mul_f32 v[70:71], v[54:55], v[102:103]
    v_pk_mul_f32 v[78:79], v[62:63], v[102:103]
    v_pk_fma_f32 v[64:65], v[56:57], v[104:105], v[64:65]
    v_pk_fma_f32 v[72:73], v[48:49], v[104:105], v[72:73] neg_lo:[1,0,0] neg_hi:[1,0,0]
    v_pk_fma_f32 v[66:67], v[58:59], v[106:107], v[66:67]
    v_pk_fma_f32 v[74:75], v[50:51], v[106:107], v[74:75] neg_lo:[1,0,0] neg_hi:[1,0,0]
    v_pk_fma_f32 v[68:69], v[60:61], v[108:109], v[68:69]
    v_pk_fma_f32 v[76:77], v[52:53], v[108:109], v[76:77] neg_lo:[1,0,0] neg_hi:[1,0,0]
    v_pk_fma_f32 v[70:71], v[62:63], v[110:111], v[70:71]
    v_pk_fma_f32 v[78:79], v[54:55], v[110:111], v[78:79] neg_lo:[1,0,0] neg_hi:[1,0,0]
    v_cvt_pk_bf16_f32 v120, v64, v65
    v_cvt_pk_bf16_f32 v121, v66, v67
    v_cvt_pk_bf16_f32 v122, v68, v69
    v_cvt_pk_bf16_f32 v123, v70, v71
    v_cvt_pk_bf16_f32 v124, v72, v73
    v_cvt_pk_bf16_f32 v125, v74, v75
    v_cvt_pk_bf16_f32 v126, v76, v77
    v_cvt_pk_bf16_f32 v127, v78, v79
    v_mfma_f32_16x16x32_bf16 v[136:139], v[120:123], v[152:155], 0
    v_mfma_f32_16x16x32_bf16 v[84:87], v[120:123], v[172:175], 0
    v_mfma_f32_16x16x32_bf16 v[140:143], v[124:127], v[152:155], 0
    v_mfma_f32_16x16x32_bf16 v[136:139], v[124:127], v[156:159], v[136:139]
    v_mfma_f32_16x16x32_bf16 v[140:143], v[120:123], v[160:163], v[140:143]
    v_cvt_pk_bf16_f32 v80, v80, v81
    v_cvt_pk_bf16_f32 v81, v82, v83
    ds_write_b64 v246, v[80:81] offset:64
    v_cvt_pk_bf16_f32 v88, v128, v129
    v_cvt_pk_bf16_f32 v89, v130, v131
    v_cvt_pk_bf16_f32 v90, v132, v133
    v_cvt_pk_bf16_f32 v91, v134, v135
    ds_write_b64 v242, v[88:89] offset:4096
    ds_write_b64 v243, v[90:91] offset:4096
    v_cvt_pk_bf16_f32 v84, v84, v85
    v_cvt_pk_bf16_f32 v85, v86, v87
    ds_write_b64 v246, v[84:85] offset:96
    v_cvt_pk_bf16_f32 v92, v136, v137
    v_cvt_pk_bf16_f32 v93, v138, v139
    v_cvt_pk_bf16_f32 v94, v140, v141
    v_cvt_pk_bf16_f32 v95, v142, v143
    ds_write_b64 v244, v[92:93] offset:6144
    ds_write_b64 v245, v[94:95] offset:6144
    v_mov_b32 v5, 1
    s_mov_b64 exec, 1
    ds_add_u32 v247, v5
    s_mov_b64 exec, -1
    s_lshr_b32 s81, s72, 1
    s_and_b32 s82, s72, 1
    s_lshl_b32 s83, s81, 13
    s_add_u32 s83, s83, 2048
    v_lshrrev_b32 v4, 1, v2
    v_xor_b32 v4, v4, v3
    v_lshlrev_b32 v4, 4, v4
    v_lshl_add_u32 v210, v2, 7, v4
    v_xor_b32 v211, 64, v210
    v_add_u32 v208, s83, v210
    v_add_u32 v209, s83, v211
    v_lshrrev_b32 v4, 3, v2
    v_and_b32 v5, 1, v3
    v_lshl_add_u32 v4, v5, 1, v4
    s_lshl_b32 s84, s82, 1
    v_xor_b32 v4, s84, v4
    v_lshlrev_b32 v4, 5, v4
    v_and_b32 v5, 3, v2
    v_lshl_add_u32 v4, v5, 3, v4
    v_lshrrev_b32 v5, 2, v2
    v_lshl_add_u32 v5, v3, 3, v5
    v_lshl_add_u32 v4, v5, 7, v4
    v_add_u32 v212, 18432, v4
    v_xor_b32 v4, 32, v4
    v_add_u32 v213, 18432, v4
b1_1_r:
    ds_read_b32 v6, v247
    ds_read_b64_tr_b16 v[16:17], v192
    ds_read_b64_tr_b16 v[18:19], v193
    ds_read_b64_tr_b16 v[20:21], v194
    ds_read_b64_tr_b16 v[22:23], v195
    ds_read_b64_tr_b16 v[24:25], v196
    ds_read_b64_tr_b16 v[26:27], v197
    ds_read_b64_tr_b16 v[28:29], v198
    ds_read_b64_tr_b16 v[30:31], v199
    ds_read_b64_tr_b16 v[32:33], v200
    ds_read_b64_tr_b16 v[34:35], v201
    s_waitcnt lgkmcnt(10)
    v_readfirstlane_b32 s81, v6
    s_nop 1
    s_cmp_lt_u32 s81, 4
    s_cbranch_scc1 b1_1_r
    s_waitcnt lgkmcnt(8)
    v_mfma_f32_16x16x32_bf16 v[36:39], v[16:19], v[164:167], 0
    v_mfma_f32_16x16x32_bf16 v[40:43], v[16:19], v[168:171], 0
    s_waitcnt lgkmcnt(6)
    v_mfma_f32_16x16x32_bf16 v[44:47], v[20:23], v[164:167], 0
    v_mfma_f32_16x16x32_bf16 v[48:51], v[20:23], v[168:171], 0
    s_waitcnt lgkmcnt(4)
    v_mfma_f32_16x16x32_bf16 v[52:55], v[24:27], v[164:167], 0
    v_mfma_f32_16x16x32_bf16 v[56:59], v[24:27], v[168:171], 0
    s_waitcnt lgkmcnt(2)
    v_mfma_f32_16x16x32_bf16 v[60:63], v[28:31], v[164:167], 0
    v_mfma_f32_16x16x32_bf16 v[64:67], v[28:31], v[168:171], 0
    s_waitcnt lgkmcnt(0)
    v_mfma_f32_16x16x32_bf16 v[68:71], v[32:35], v[164:167], 0
    v_mfma_f32_16x16x32_bf16 v[72:75], v[32:35], v[168:171], 0
    s_bitcmp1_b32 s77, 3
    s_cbranch_scc1 b1_1_sw
    v_cvt_pk_bf16_f32 v76, v36, v37
    v_cvt_pk_bf16_f32 v77, v38, v39
    v_cvt_pk_bf16_f32 v78, v40, v41
    v_cvt_pk_bf16_f32 v79, v42, v43
    ds_write_b128 v202, v[76:79] offset:0
    v_cvt_pk_bf16_f32 v80, v44, v45
    v_cvt_pk_bf16_f32 v81, v46, v47
    v_cvt_pk_bf16_f32 v82, v48, v49
    v_cvt_pk_bf16_f32 v83, v50, v51
    ds_write_b128 v202, v[80:83] offset:2048
    v_cvt_pk_bf16_f32 v84, v52, v53
    v_cvt_pk_bf16_f32 v85, v54, v55
    v_cvt_pk_bf16_f32 v86, v56, v57
    v_cvt_pk_bf16_f32 v87, v58, v59
    ds_write_b128 v202, v[84:87] offset:4096
    v_cvt_pk_bf16_f32 v88, v60, v61
    v_cvt_pk_bf16_f32 v89, v62, v63
    v_cvt_pk_bf16_f32 v90, v64, v65
    v_cvt_pk_bf16_f32 v91, v66, v67
    ds_write_b128 v202, v[88:91] offset:6144
    v_cvt_pk_bf16_f32 v92, v68, v69
    v_cvt_pk_bf16_f32 v93, v70, v71
    v_cvt_pk_bf16_f32 v94, v72, v73
    v_cvt_pk_bf16_f32 v95, v74, v75
    s_branch b1_1_x
b1_1_sw:
    v_cvt_pk_bf16_f32 v78, v36, v37
    v_cvt_pk_bf16_f32 v79, v38, v39
    v_cvt_pk_bf16_f32 v76, v40, v41
    v_cvt_pk_bf16_f32 v77, v42, v43
    ds_write_b128 v202, v[76:79] offset:0
    v_cvt_pk_bf16_f32 v82, v44, v45
    v_cvt_pk_bf16_f32 v83, v46, v47
    v_cvt_pk_bf16_f32 v80, v48, v49
    v_cvt_pk_bf16_f32 v81, v50, v51
    ds_write_b128 v202, v[80:83] offset:2048
    v_cvt_pk_bf16_f32 v86, v52, v53
    v_cvt_pk_bf16_f32 v87, v54, v55
    v_cvt_pk_bf16_f32 v84, v56, v57
    v_cvt_pk_bf16_f32 v85, v58, v59
    ds_write_b128 v202, v[84:87] offset:4096
    v_cvt_pk_bf16_f32 v90, v60, v61
    v_cvt_pk_bf16_f32 v91, v62, v63
    v_cvt_pk_bf16_f32 v88, v64, v65
    v_cvt_pk_bf16_f32 v89, v66, v67
    ds_write_b128 v202, v[88:91] offset:6144
    v_cvt_pk_bf16_f32 v94, v68, v69
    v_cvt_pk_bf16_f32 v95, v70, v71
    v_cvt_pk_bf16_f32 v92, v72, v73
    v_cvt_pk_bf16_f32 v93, v74, v75
b1_1_x:
    ds_write_b128 v203, v[92:95]
    s_cmp_ge_u32 s72, 2
    s_cbranch_scc1 L_th1
    s_mov_b32 s90, 0
    s_mov_b32 s89, 0
    v_add_u32 v214, s90, v208
    v_add_u32 v215, s90, v209
    v_add_u32 v216, s90, v210
    v_add_u32 v217, s90, v211
    v_add_u32 v218, s90, v212
    v_add_u32 v219, s90, v213
    s_mov_b32 s90, 43008
    s_barrier
    ds_read_b64_tr_b16 v[140:141], v218 offset:0
    ds_read_b64_tr_b16 v[142:143], v218 offset:512
    ds_read_b128 v[124:127], v214 offset:0
    ds_read_b128 v[128:131], v214 offset:2048
    ds_read_b128 v[132:135], v214 offset:4096
    ds_read_b128 v[136:139], v214 offset:6144
    ds_read_b64_tr_b16 v[144:145], v219 offset:0
    ds_read_b64_tr_b16 v[146:147], v219 offset:512
    ds_read_b64_tr_b16 v[148:149], v218 offset:8192
    ds_read_b64_tr_b16 v[150:151], v218 offset:8704
    ds_read_b64_tr_b16 v[152:153], v219 offset:8192
    ds_read_b64_tr_b16 v[154:155], v219 offset:8704
    ds_read_b64_tr_b16 v[156:157], v218 offset:16384
    ds_read_b64_tr_b16 v[158:159], v218 offset:16896
    ds_read_b64_tr_b16 v[160:161], v219 offset:16384
    ds_read_b64_tr_b16 v[162:163], v219 offset:16896
    ds_read_b128 v[120:123], v216
    s_waitcnt lgkmcnt(0)
    v_mfma_f32_16x16x32_bf16 v[16:19], v[140:143], v[124:127], 0
    ds_read_b64_tr_b16 v[184:185], v218 offset:4096
    v_mfma_f32_16x16x32_bf16 v[24:27], v[140:143], v[128:131], 0
    ds_read_b64_tr_b16 v[186:187], v218 offset:4608
    v_mfma_f32_16x16x32_bf16 v[32:35], v[140:143], v[132:135], 0
    ds_read_b128 v[168:171], v215 offset:0
    v_mfma_f32_16x16x32_bf16 v[40:43], v[140:143], v[136:139], 0
    ds_read_b128 v[172:175], v215 offset:2048
    v_mfma_f32_16x16x32_bf16 v[44:47], v[144:147], v[136:139], 0
    ds_read_b128 v[176:179], v215 offset:4096
    v_mfma_f32_16x16x32_bf16 v[36:39], v[144:147], v[132:135], 0
    ds_read_b128 v[180:183], v215 offset:6144
    v_mfma_f32_16x16x32_bf16 v[28:31], v[144:147], v[128:131], 0
    ds_read_b64_tr_b16 v[188:189], v219 offset:4096
    v_mfma_f32_16x16x32_bf16 v[20:23], v[144:147], v[124:127], 0
    ds_read_b64_tr_b16 v[190:191], v219 offset:4608
    v_mfma_f32_16x16x32_bf16 v[48:51], v[148:151], v[124:127], 0
    ds_read_b64_tr_b16 v[192:193], v218 offset:12288
    v_mfma_f32_16x16x32_bf16 v[56:59], v[148:151], v[128:131], 0
    ds_read_b64_tr_b16 v[194:195], v218 offset:12800
    v_mfma_f32_16x16x32_bf16 v[64:67], v[148:151], v[132:135], 0
    ds_read_b64_tr_b16 v[196:197], v219 offset:12288
    v_mfma_f32_16x16x32_bf16 v[72:75], v[148:151], v[136:139], 0
    ds_read_b64_tr_b16 v[198:199], v219 offset:12800
    v_mfma_f32_16x16x32_bf16 v[76:79], v[152:155], v[136:139], 0
    ds_read_b64_tr_b16 v[200:201], v218 offset:20480
    v_mfma_f32_16x16x32_bf16 v[68:71], v[152:155], v[132:135], 0
    ds_read_b64_tr_b16 v[202:203], v218 offset:20992
    v_mfma_f32_16x16x32_bf16 v[60:63], v[152:155], v[128:131], 0
    ds_read_b64_tr_b16 v[204:205], v219 offset:20480
    v_mfma_f32_16x16x32_bf16 v[52:55], v[152:155], v[124:127], 0
    ds_read_b64_tr_b16 v[206:207], v219 offset:20992
    v_mfma_f32_16x16x32_bf16 v[80:83], v[124:127], v[156:159], 0
    ds_read_b128 v[164:167], v217
    v_mfma_f32_16x16x32_bf16 v[88:91], v[128:131], v[156:159], 0
    v_add_u32 v214, s90, v208
    v_mfma_f32_16x16x32_bf16 v[96:99], v[132:135], v[156:159], 0
    v_add_u32 v216, s90, v210
    v_mfma_f32_16x16x32_bf16 v[104:107], v[136:139], v[156:159], 0
    v_add_u32 v218, s90, v212
    v_mfma_f32_16x16x32_bf16 v[108:111], v[136:139], v[160:163], 0
    v_add_u32 v219, s90, v213
    v_mfma_f32_16x16x32_bf16 v[100:103], v[132:135], v[160:163], 0
    v_mfma_f32_16x16x32_bf16 v[92:95], v[128:131], v[160:163], 0
    v_mfma_f32_16x16x32_bf16 v[84:87], v[124:127], v[160:163], 0
    v_mfma_f32_16x16x32_bf16 v[112:115], v[148:151], v[120:123], 0
    v_mfma_f32_16x16x32_bf16 v[116:119], v[152:155], v[120:123], 0
    s_lshr_b32 s81, s72, 1
    v_and_b32 v4, 1, v2
    v_lshl_add_u32 v5, v3, 2, v4
    v_add_u32 v6, 2, v5
    v_lshlrev_b32 v7, 1, v4
    v_cmp_le_u32 s[86:87], v5, v2
    v_cmp_le_u32 vcc, v6, v2
    v_add_u32 v8, 4, v7
    s_nop 0
    v_cndmask_b32 v5, v7, v8, s[86:87]
    v_cndmask_b32 v6, v7, v8, vcc
    s_mov_b32 s84, 0x01010000
    v_mul_lo_u32 v5, v5, s84
    v_add_u32 v220, 0x01000c0c, v5
    v_mul_lo_u32 v6, v6, s84
    v_add_u32 v221, 0x01000c0c, v6
    v_lshlrev_b32 v4, 4, v4
    v_mov_b32 v9, 0x0c0c0c0c
    v_mov_b32 v7, 0xc0c0100
    v_alignbit_b32 v7, v7, v7, v4
    v_cndmask_b32 v222, v7, v9, s[86:87]
    v_cndmask_b32 v224, v9, v7, s[86:87]
    v_mov_b32 v7, 0xc0c0302
    v_alignbit_b32 v7, v7, v7, v4
    v_cndmask_b32 v223, v7, v9, vcc
    v_cndmask_b32 v225, v9, v7, vcc
    s_or_b32 s84, s73, s81
    s_cmp_eq_u32 s84, 0
    s_cselect_b32 s84, 0xce6e6b28, 0
    v_mov_b32 v7, s84
    v_cndmask_b32 v226, v7, 0, s[86:87]
    v_cndmask_b32 v227, v7, 0, vcc
    s_waitcnt lgkmcnt(0)
    s_barrier
    s_branch qkv_2_in
.p2align 6
qkv_2:
    v_mfma_f32_16x16x32_bf16 v[84:87], v[124:127], v[160:163], v[84:87]
    s_barrier
    v_mfma_f32_16x16x32_bf16 v[112:115], v[148:151], v[120:123], v[112:115]
    v_mfma_f32_16x16x32_bf16 v[116:119], v[152:155], v[120:123], v[116:119]
qkv_2_in:
    v_mfma_f32_16x16x32_bf16 v[16:19], v[184:187], v[168:171], v[16:19]
    ds_read_b64_tr_b16 v[140:141], v218 offset:0
    v_mfma_f32_16x16x32_bf16 v[24:27], v[184:187], v[172:175], v[24:27]
    ds_read_b64_tr_b16 v[142:143], v218 offset:512
    v_mfma_f32_16x16x32_bf16 v[32:35], v[184:187], v[176:179], v[32:35]
    ds_read_b128 v[124:127], v214 offset:0
    v_mfma_f32_16x16x32_bf16 v[40:43], v[184:187], v[180:183], v[40:43]
    ds_read_b128 v[128:131], v214 offset:2048
    v_mfma_f32_16x16x32_bf16 v[44:47], v[188:191], v[180:183], v[44:47]
    ds_read_b128 v[132:135], v214 offset:4096
    v_mfma_f32_16x16x32_bf16 v[36:39], v[188:191], v[176:179], v[36:39]
    ds_read_b128 v[136:139], v214 offset:6144
    v_mfma_f32_16x16x32_bf16 v[28:31], v[188:191], v[172:175], v[28:31]
    ds_read_b64_tr_b16 v[144:145], v219 offset:0
    v_mfma_f32_16x16x32_bf16 v[20:23], v[188:191], v[168:171], v[20:23]
    ds_read_b64_tr_b16 v[146:147], v219 offset:512
    v_mfma_f32_16x16x32_bf16 v[48:51], v[192:195], v[168:171], v[48:51]
    ds_read_b64_tr_b16 v[148:149], v218 offset:8192
    v_mfma_f32_16x16x32_bf16 v[56:59], v[192:195], v[172:175], v[56:59]
    ds_read_b64_tr_b16 v[150:151], v218 offset:8704
    v_mfma_f32_16x16x32_bf16 v[64:67], v[192:195], v[176:179], v[64:67]
    ds_read_b64_tr_b16 v[152:153], v219 offset:8192
    v_mfma_f32_16x16x32_bf16 v[72:75], v[192:195], v[180:183], v[72:75]
    ds_read_b64_tr_b16 v[154:155], v219 offset:8704
    v_mfma_f32_16x16x32_bf16 v[76:79], v[196:199], v[180:183], v[76:79]
    ds_read_b64_tr_b16 v[156:157], v218 offset:16384
    v_mfma_f32_16x16x32_bf16 v[68:71], v[196:199], v[176:179], v[68:71]
    ds_read_b64_tr_b16 v[158:159], v218 offset:16896
    v_mfma_f32_16x16x32_bf16 v[60:63], v[196:199], v[172:175], v[60:63]
    ds_read_b64_tr_b16 v[160:161], v219 offset:16384
    v_mfma_f32_16x16x32_bf16 v[52:55], v[196:199], v[168:171], v[52:55]
    ds_read_b64_tr_b16 v[162:163], v219 offset:16896
    v_mfma_f32_16x16x32_bf16 v[80:83], v[168:171], v[200:203], v[80:83]
    ds_read_b128 v[120:123], v216
    v_mfma_f32_16x16x32_bf16 v[88:91], v[172:175], v[200:203], v[88:91]
    v_add_u32 v215, s90, v209
    v_mfma_f32_16x16x32_bf16 v[96:99], v[176:179], v[200:203], v[96:99]
    v_add_u32 v217, s90, v211
    v_mfma_f32_16x16x32_bf16 v[104:107], v[180:183], v[200:203], v[104:107]
    s_add_u32 s90, s90, 43008
    v_mfma_f32_16x16x32_bf16 v[108:111], v[180:183], v[204:207], v[108:111]
    s_cmp_eq_u32 s90, 129024
    v_mfma_f32_16x16x32_bf16 v[100:103], v[176:179], v[204:207], v[100:103]
    s_cselect_b32 s90, 0, s90
    v_mfma_f32_16x16x32_bf16 v[92:95], v[172:175], v[204:207], v[92:95]
    v_mfma_f32_16x16x32_bf16 v[84:87], v[168:171], v[204:207], v[84:87]
    v_mfma_f32_16x16x32_bf16 v[112:115], v[192:195], v[164:167], v[112:115]
    s_waitcnt lgkmcnt(0)
    v_mfma_f32_16x16x32_bf16 v[116:119], v[196:199], v[164:167], v[116:119]
    v_mfma_f32_16x16x32_bf16 v[16:19], v[140:143], v[124:127], v[16:19]
    ds_read_b64_tr_b16 v[184:185], v218 offset:4096
    v_mfma_f32_16x16x32_bf16 v[24:27], v[140:143], v[128:131], v[24:27]
    ds_read_b64_tr_b16 v[186:187], v218 offset:4608
    v_mfma_f32_16x16x32_bf16 v[32:35], v[140:143], v[132:135], v[32:35]
    ds_read_b128 v[168:171], v215 offset:0
    v_mfma_f32_16x16x32_bf16 v[40:43], v[140:143], v[136:139], v[40:43]
    ds_read_b128 v[172:175], v215 offset:2048
    v_mfma_f32_16x16x32_bf16 v[44:47], v[144:147], v[136:139], v[44:47]
    ds_read_b128 v[176:179], v215 offset:4096
    v_mfma_f32_16x16x32_bf16 v[36:39], v[144:147], v[132:135], v[36:39]
    ds_read_b128 v[180:183], v215 offset:6144
    v_mfma_f32_16x16x32_bf16 v[28:31], v[144:147], v[128:131], v[28:31]
    ds_read_b64_tr_b16 v[188:189], v219 offset:4096
    v_mfma_f32_16x16x32_bf16 v[20:23], v[144:147], v[124:127], v[20:23]
    ds_read_b64_tr_b16 v[190:191], v219 offset:4608
    v_mfma_f32_16x16x32_bf16 v[48:51], v[148:151], v[124:127], v[48:51]
    ds_read_b64_tr_b16 v[192:193], v218 offset:12288
    v_mfma_f32_16x16x32_bf16 v[56:59], v[148:151], v[128:131], v[56:59]
    ds_read_b64_tr_b16 v[194:195], v218 offset:12800
    v_mfma_f32_16x16x32_bf16 v[64:67], v[148:151], v[132:135], v[64:67]
    ds_read_b64_tr_b16 v[196:197], v219 offset:12288
    v_mfma_f32_16x16x32_bf16 v[72:75], v[148:151], v[136:139], v[72:75]
    ds_read_b64_tr_b16 v[198:199], v219 offset:12800
    v_mfma_f32_16x16x32_bf16 v[76:79], v[152:155], v[136:139], v[76:79]
    ds_read_b64_tr_b16 v[200:201], v218 offset:20480
    v_mfma_f32_16x16x32_bf16 v[68:71], v[152:155], v[132:135], v[68:71]
    ds_read_b64_tr_b16 v[202:203], v218 offset:20992
    v_mfma_f32_16x16x32_bf16 v[60:63], v[152:155], v[128:131], v[60:63]
    ds_read_b64_tr_b16 v[204:205], v219 offset:20480
    v_mfma_f32_16x16x32_bf16 v[52:55], v[152:155], v[124:127], v[52:55]
    ds_read_b64_tr_b16 v[206:207], v219 offset:20992
    v_mfma_f32_16x16x32_bf16 v[80:83], v[124:127], v[156:159], v[80:83]
    ds_read_b128 v[164:167], v217
    v_mfma_f32_16x16x32_bf16 v[88:91], v[128:131], v[156:159], v[88:91]
    v_add_u32 v214, s90, v208
    v_mfma_f32_16x16x32_bf16 v[96:99], v[132:135], v[156:159], v[96:99]
    v_add_u32 v216, s90, v210
    v_mfma_f32_16x16x32_bf16 v[104:107], v[136:139], v[156:159], v[104:107]
    v_add_u32 v218, s90, v212
    v_mfma_f32_16x16x32_bf16 v[108:111], v[136:139], v[160:163], v[108:111]
    v_add_u32 v219, s90, v213
    v_mfma_f32_16x16x32_bf16 v[100:103], v[132:135], v[160:163], v[100:103]
    s_add_u32 s89, s89, 1
    s_cmp_lt_u32 s89, 15
    s_waitcnt lgkmcnt(0)
    v_mfma_f32_16x16x32_bf16 v[92:95], v[128:131], v[160:163], v[92:95]
    s_cbranch_scc1 qkv_2
    v_mfma_f32_16x16x32_bf16 v[84:87], v[124:127], v[160:163], v[84:87]
    v_mfma_f32_16x16x32_bf16 v[112:115], v[148:151], v[120:123], v[112:115]
    v_mfma_f32_16x16x32_bf16 v[116:119], v[152:155], v[120:123], v[116:119]
    v_mfma_f32_16x16x32_bf16 v[16:19], v[184:187], v[168:171], v[16:19]
    v_mfma_f32_16x16x32_bf16 v[24:27], v[184:187], v[172:175], v[24:27]
    v_mfma_f32_16x16x32_bf16 v[32:35], v[184:187], v[176:179], v[32:35]
    v_mfma_f32_16x16x32_bf16 v[40:43], v[184:187], v[180:183], v[40:43]
    v_mfma_f32_16x16x32_bf16 v[44:47], v[188:191], v[180:183], v[44:47]
    v_mfma_f32_16x16x32_bf16 v[36:39], v[188:191], v[176:179], v[36:39]
    v_mfma_f32_16x16x32_bf16 v[28:31], v[188:191], v[172:175], v[28:31]
    v_mfma_f32_16x16x32_bf16 v[20:23], v[188:191], v[168:171], v[20:23]
    v_mfma_f32_16x16x32_bf16 v[48:51], v[192:195], v[168:171], v[48:51]
    v_mfma_f32_16x16x32_bf16 v[56:59], v[192:195], v[172:175], v[56:59]
    v_mfma_f32_16x16x32_bf16 v[64:67], v[192:195], v[176:179], v[64:67]
    v_mfma_f32_16x16x32_bf16 v[72:75], v[192:195], v[180:183], v[72:75]
    v_mfma_f32_16x16x32_bf16 v[76:79], v[196:199], v[180:183], v[76:79]
    v_mfma_f32_16x16x32_bf16 v[68:71], v[196:199], v[176:179], v[68:71]
    v_mfma_f32_16x16x32_bf16 v[60:63], v[196:199], v[172:175], v[60:63]
    v_mfma_f32_16x16x32_bf16 v[52:55], v[196:199], v[168:171], v[52:55]
    v_mfma_f32_16x16x32_bf16 v[80:83], v[168:171], v[200:203], v[80:83]
    v_mfma_f32_16x16x32_bf16 v[88:91], v[172:175], v[200:203], v[88:91]
    v_mfma_f32_16x16x32_bf16 v[96:99], v[176:179], v[200:203], v[96:99]
    v_mfma_f32_16x16x32_bf16 v[104:107], v[180:183], v[200:203], v[104:107]
    v_mfma_f32_16x16x32_bf16 v[108:111], v[180:183], v[204:207], v[108:111]
    v_mfma_f32_16x16x32_bf16 v[100:103], v[176:179], v[204:207], v[100:103]
    v_mfma_f32_16x16x32_bf16 v[92:95], v[172:175], v[204:207], v[92:95]
    v_mfma_f32_16x16x32_bf16 v[84:87], v[168:171], v[204:207], v[84:87]
    v_mfma_f32_16x16x32_bf16 v[112:115], v[192:195], v[164:167], v[112:115]
    v_mfma_f32_16x16x32_bf16 v[116:119], v[196:199], v[164:167], v[116:119]
    s_and_b32 s82, s72, 1
    s_mul_i32 s82, s82, 3072
    s_add_u32 s82, s82, 149504
    v_lshlrev_b32 v15, 4, v1
    v_add_u32 v14, s82, v15
    s_and_b32 s82, s72, 1
    s_lshl_b32 s82, s82, 2
    s_add_u32 s82, s82, 155656
    v_mov_b32 v13, s82
    v_cvt_pk_bf16_f32 v152, v72, v73
    v_cvt_pk_bf16_f32 v153, v74, v75
    v_cvt_pk_bf16_f32 v154, v76, v77
    v_cvt_pk_bf16_f32 v155, v78, v79
    ds_write_b128 v14, v[152:155]
    v_cvt_pk_bf16_f32 v164, v104, v105
    v_cvt_pk_bf16_f32 v165, v106, v107
    ds_write_b64 v14, v[164:165] offset:1024
    v_cvt_pk_bf16_f32 v174, v108, v109
    v_cvt_pk_bf16_f32 v175, v110, v111
    ds_write_b64 v14, v[174:175] offset:1032
    v_mov_b32 v5, 1
    s_mov_b64 exec, 1
    ds_add_u32 v13, v5
    s_mov_b64 exec, -1
    v_cvt_pk_bf16_f32 v120, v16, v17
    v_cvt_pk_bf16_f32 v121, v18, v19
    v_cvt_pk_bf16_f32 v122, v20, v21
    v_cvt_pk_bf16_f32 v123, v22, v23
    v_cvt_pk_bf16_f32 v124, v24, v25
    v_cvt_pk_bf16_f32 v125, v26, v27
    v_cvt_pk_bf16_f32 v126, v28, v29
    v_cvt_pk_bf16_f32 v127, v30, v31
    v_cvt_pk_bf16_f32 v128, v32, v33
    v_cvt_pk_bf16_f32 v129, v34, v35
    v_cvt_pk_bf16_f32 v130, v36, v37
    v_cvt_pk_bf16_f32 v131, v38, v39
    v_cvt_pk_bf16_f32 v132, v40, v41
    v_cvt_pk_bf16_f32 v133, v42, v43
    v_cvt_pk_bf16_f32 v134, v44, v45
    v_cvt_pk_bf16_f32 v135, v46, v47
    v_cvt_pk_bf16_f32 v136, v112, v113
    v_cvt_pk_bf16_f32 v137, v114, v115
    v_cvt_pk_bf16_f32 v138, v116, v117
    v_cvt_pk_bf16_f32 v139, v118, v119
    v_cvt_pk_bf16_f32 v140, v48, v49
    v_cvt_pk_bf16_f32 v141, v50, v51
    v_cvt_pk_bf16_f32 v142, v52, v53
    v_cvt_pk_bf16_f32 v143, v54, v55
    v_cvt_pk_bf16_f32 v144, v56, v57
    v_cvt_pk_bf16_f32 v145, v58, v59
    v_cvt_pk_bf16_f32 v146, v60, v61
    v_cvt_pk_bf16_f32 v147, v62, v63
    v_cvt_pk_bf16_f32 v148, v64, v65
    v_cvt_pk_bf16_f32 v149, v66, v67
    v_cvt_pk_bf16_f32 v150, v68, v69
    v_cvt_pk_bf16_f32 v151, v70, v71
ex_3:
    ds_read_b32 v6, v13
    ds_read_b64 v[156:157], v14 offset:2048
    ds_read_b64 v[166:167], v14 offset:2056
    v_mfma_f32_16x16x32_bf16 v[44:47], v[152:155], v[132:135], 0
    v_mfma_f32_16x16x32_bf16 v[40:43], v[148:151], v[132:135], 0
    v_mfma_f32_16x16x32_bf16 v[36:39], v[148:151], v[128:131], 0
    v_mfma_f32_16x16x32_bf16 v[32:35], v[144:147], v[128:131], 0
    v_mfma_f32_16x16x32_bf16 v[28:31], v[144:147], v[124:127], 0
    v_mfma_f32_16x16x32_bf16 v[24:27], v[140:143], v[124:127], 0
    v_mfma_f32_16x16x32_bf16 v[20:23], v[140:143], v[120:123], 0
    v_mfma_f32_16x16x32_bf16 v[16:19], v[136:139], v[120:123], 0
    s_waitcnt lgkmcnt(0)
    v_readfirstlane_b32 s81, v6
    s_nop 1
    s_cmp_lt_u32 s81, 2
    s_cbranch_scc1 ex_3
    s_mov_b32 s83, 0x3e3504f3
    s_mov_b32 s84, 0x3fb8aa3b
    s_mov_b32 s85, 0xbfb8aa3b
    v_cvt_pk_bf16_f32 v188, v40, v41
    v_cvt_pk_bf16_f32 v189, v42, v43
    v_cvt_pk_bf16_f32 v190, v44, v45
    v_cvt_pk_bf16_f32 v191, v46, v47
    v_cvt_pk_bf16_f32 v184, v32, v33
    v_cvt_pk_bf16_f32 v185, v34, v35
    v_cvt_pk_bf16_f32 v186, v36, v37
    v_cvt_pk_bf16_f32 v187, v38, v39
    v_cvt_pk_bf16_f32 v180, v24, v25
    v_cvt_pk_bf16_f32 v181, v26, v27
    v_cvt_pk_bf16_f32 v182, v28, v29
    v_cvt_pk_bf16_f32 v183, v30, v31
    v_cvt_pk_bf16_f32 v176, v16, v17
    v_cvt_pk_bf16_f32 v177, v18, v19
    v_cvt_pk_bf16_f32 v178, v20, v21
    v_cvt_pk_bf16_f32 v179, v22, v23
    v_perm_b32 v198, v190, v188, v220
    v_perm_b32 v199, v191, v189, v221
    v_perm_b32 v196, v186, v184, v220
    v_perm_b32 v197, v187, v185, v221
    v_perm_b32 v194, v182, v180, v220
    v_perm_b32 v195, v183, v181, v221
    v_perm_b32 v192, v178, v176, v220
    v_perm_b32 v193, v179, v177, v221
    v_mul_f32 v198, s83, v198
    v_mul_f32 v199, s83, v199
    v_mul_f32 v196, s83, v196
    v_mul_f32 v197, s83, v197
    v_mul_f32 v194, s83, v194
    v_mul_f32 v195, s83, v195
    v_fma_f32 v192, v192, s83, v226
    v_fma_f32 v193, v193, s83, v227
    v_cvt_pk_bf16_f32 v203, v198, v199
    v_cvt_pk_bf16_f32 v202, v196, v197
    v_cvt_pk_bf16_f32 v201, v194, v195
    v_cvt_pk_bf16_f32 v200, v192, v193
    v_lshlrev_b32 v198, 16, v203
    v_and_b32 v199, 0xffff0000, v203
    v_lshlrev_b32 v196, 16, v202
    v_and_b32 v197, 0xffff0000, v202
    v_lshlrev_b32 v194, 16, v201
    v_and_b32 v195, 0xffff0000, v201
    v_lshlrev_b32 v192, 16, v200
    v_and_b32 v193, 0xffff0000, v200
    v_max_f32 v203, v198, v199
    v_max_f32 v202, v196, v197
    v_max_f32 v201, v194, v195
    v_max_f32 v200, v192, v193
    s_nop 1
    v_permlane16_swap_b32 v200, v201
    v_cvt_pk_bf16_f32 v158, v80, v81
    v_permlane16_swap_b32 v202, v203
    v_cvt_pk_bf16_f32 v159, v82, v83
    v_max_f32 v200, v200, v201
    v_cvt_pk_bf16_f32 v168, v84, v85
    v_max_f32 v202, v202, v203
    v_cvt_pk_bf16_f32 v169, v86, v87
    s_nop 0
    v_permlane32_swap_b32 v200, v202
    v_cvt_pk_bf16_f32 v160, v88, v89
    v_max_f32 v200, v200, v202
    v_cvt_pk_bf16_f32 v161, v90, v91
    v_mul_f32 v200, s85, v200
    v_mov_b32 v202, v200
    v_cvt_pk_bf16_f32 v170, v92, v93
    s_nop 0
    v_permlane32_swap_b32 v200, v202
    v_cvt_pk_bf16_f32 v171, v94, v95
    v_mov_b32 v201, v200
    v_cvt_pk_bf16_f32 v162, v96, v97
    v_mov_b32 v203, v202
    v_cvt_pk_bf16_f32 v163, v98, v99
    v_permlane16_swap_b32 v200, v201
    v_cvt_pk_bf16_f32 v172, v100, v101
    v_permlane16_swap_b32 v202, v203
    v_cvt_pk_bf16_f32 v173, v102, v103
    v_fma_f32 v198, v198, s84, v203
    v_fma_f32 v199, v199, s84, v203
    v_fma_f32 v196, v196, s84, v202
    v_fma_f32 v197, v197, s84, v202
    v_fma_f32 v194, v194, s84, v201
    v_fma_f32 v195, v195, s84, v201
    v_fma_f32 v192, v192, s84, v200
    v_fma_f32 v193, v193, s84, v200
    v_exp_f32 v199, v199
    v_exp_f32 v198, v198
    v_exp_f32 v197, v197
    v_exp_f32 v196, v196
    v_exp_f32 v195, v195
    v_exp_f32 v194, v194
    v_exp_f32 v193, v193
    v_exp_f32 v192, v192
    v_add_f32 v203, v198, v199
    v_add_f32 v202, v196, v197
    v_add_f32 v201, v194, v195
    v_add_f32 v200, v192, v193
    s_nop 1
    v_permlane16_swap_b32 v200, v201
    v_permlane16_swap_b32 v202, v203
    v_add_f32 v200, v200, v201
    v_add_f32 v202, v202, v203
    s_nop 1
    v_permlane32_swap_b32 v200, v202
    v_add_f32 v200, v200, v202
    v_rcp_f32 v200, v200
    s_nop 0
    v_mov_b32 v202, v200
    s_nop 1
    v_permlane32_swap_b32 v200, v202
    v_mov_b32 v201, v200
    v_mov_b32 v203, v202
    s_nop 0
    v_permlane16_swap_b32 v200, v201
    v_permlane16_swap_b32 v202, v203
    v_mul_f32 v198, v198, v203
    v_mul_f32 v199, v199, v203
    v_mul_f32 v196, v196, v202
    v_mul_f32 v197, v197, v202
    v_mul_f32 v194, v194, v201
    v_mul_f32 v195, v195, v201
    v_mul_f32 v192, v192, v200
    v_mul_f32 v193, v193, v200
    v_cvt_pk_bf16_f32 v203, v198, v199
    v_cvt_pk_bf16_f32 v202, v196, v197
    v_cvt_pk_bf16_f32 v201, v194, v195
    v_cvt_pk_bf16_f32 v200, v192, v193
    v_perm_b32 v188, v203, v203, v222
    v_perm_b32 v189, v203, v203, v223
    v_perm_b32 v190, v203, v203, v224
    v_perm_b32 v191, v203, v203, v225
    v_perm_b32 v184, v202, v202, v222
    v_perm_b32 v185, v202, v202, v223
    v_perm_b32 v186, v202, v202, v224
    v_perm_b32 v187, v202, v202, v225
    v_perm_b32 v180, v201, v201, v222
    v_perm_b32 v181, v201, v201, v223
    v_perm_b32 v182, v201, v201, v224
    v_perm_b32 v183, v201, v201, v225
    v_perm_b32 v176, v200, v200, v222
    v_perm_b32 v177, v200, v200, v223
    v_perm_b32 v178, v200, v200, v224
    v_perm_b32 v179, v200, v200, v225
    s_lshl_b32 s81, s73, 3
    s_add_u32 s81, s81, 0
    s_lshl_b32 s81, s81, 5
    s_lshl_b32 s82, s74, 1
    s_add_u32 s81, s81, s82
    s_and_b32 s82, s72, 1
    s_add_u32 s81, s81, s82
    s_lshl_b32 s81, s81, 10
    v_mfma_f32_16x16x32_bf16 v[72:75], v[162:165], v[188:191], 0
    v_mfma_f32_16x16x32_bf16 v[76:79], v[172:175], v[188:191], 0
    v_mfma_f32_16x16x32_bf16 v[64:67], v[160:163], v[184:187], 0
    v_mfma_f32_16x16x32_bf16 v[68:71], v[170:173], v[184:187], 0
    v_mfma_f32_16x16x32_bf16 v[56:59], v[158:161], v[180:183], 0
    v_mfma_f32_16x16x32_bf16 v[60:63], v[168:171], v[180:183], 0
    v_mfma_f32_16x16x32_bf16 v[48:51], v[156:159], v[176:179], 0
    v_mfma_f32_16x16x32_bf16 v[52:55], v[166:169], v[176:179], 0
    s_nop 0
    v_cvt_pk_bf16_f32 v92, v72, v73
    v_cvt_pk_bf16_f32 v93, v74, v75
    v_cvt_pk_bf16_f32 v94, v76, v77
    v_cvt_pk_bf16_f32 v95, v78, v79
    s_add_u32 s82, s81, 98304
    buffer_store_dwordx4 v[92:95], v15, s[64:67], s82 offen sc1
    v_cvt_pk_bf16_f32 v88, v64, v65
    v_cvt_pk_bf16_f32 v89, v66, v67
    v_cvt_pk_bf16_f32 v90, v68, v69
    v_cvt_pk_bf16_f32 v91, v70, v71
    s_add_u32 s82, s81, 65536
    buffer_store_dwordx4 v[88:91], v15, s[64:67], s82 offen sc1
    v_cvt_pk_bf16_f32 v84, v56, v57
    v_cvt_pk_bf16_f32 v85, v58, v59
    v_cvt_pk_bf16_f32 v86, v60, v61
    v_cvt_pk_bf16_f32 v87, v62, v63
    s_add_u32 s82, s81, 32768
    buffer_store_dwordx4 v[84:87], v15, s[64:67], s82 offen sc1
    v_cvt_pk_bf16_f32 v80, v48, v49
    v_cvt_pk_bf16_f32 v81, v50, v51
    v_cvt_pk_bf16_f32 v82, v52, v53
    v_cvt_pk_bf16_f32 v83, v54, v55
    s_add_u32 s82, s81, 0
    buffer_store_dwordx4 v[80:83], v15, s[64:67], s82 offen sc1
    v_mov_b32 v4, 155664
    v_mov_b32 v5, 1
    s_mov_b64 exec, 1
    ds_add_u32 v4, v5
    s_mov_b64 exec, -1
    s_branch L_cj
L_th1:
    s_mov_b32 s90, 0
    s_mov_b32 s89, 0
    v_add_u32 v214, s90, v208
    v_add_u32 v215, s90, v209
    v_add_u32 v216, s90, v210
    v_add_u32 v217, s90, v211
    v_add_u32 v218, s90, v212
    v_add_u32 v219, s90, v213
    s_mov_b32 s90, 43008
    s_barrier
    ds_read_b64_tr_b16 v[140:141], v218 offset:0
    ds_read_b64_tr_b16 v[142:143], v218 offset:512
    ds_read_b128 v[124:127], v214 offset:0
    ds_read_b128 v[128:131], v214 offset:2048
    ds_read_b128 v[132:135], v214 offset:4096
    ds_read_b128 v[136:139], v214 offset:6144
    ds_read_b64_tr_b16 v[144:145], v219 offset:0
    ds_read_b64_tr_b16 v[146:147], v219 offset:512
    ds_read_b64_tr_b16 v[148:149], v218 offset:8192
    ds_read_b64_tr_b16 v[150:151], v218 offset:8704
    ds_read_b64_tr_b16 v[152:153], v219 offset:8192
    ds_read_b64_tr_b16 v[154:155], v219 offset:8704
    ds_read_b64_tr_b16 v[156:157], v218 offset:16384
    ds_read_b64_tr_b16 v[158:159], v218 offset:16896
    ds_read_b64_tr_b16 v[160:161], v219 offset:16384
    ds_read_b64_tr_b16 v[162:163], v219 offset:16896
    ds_read_b128 v[120:123], v216
    s_waitcnt lgkmcnt(0)
    v_mfma_f32_16x16x32_bf16 v[16:19], v[140:143], v[124:127], 0
    ds_read_b64_tr_b16 v[184:185], v218 offset:4096
    v_mfma_f32_16x16x32_bf16 v[24:27], v[140:143], v[128:131], 0
    ds_read_b64_tr_b16 v[186:187], v218 offset:4608
    v_mfma_f32_16x16x32_bf16 v[32:35], v[140:143], v[132:135], 0
    ds_read_b128 v[168:171], v215 offset:0
    v_mfma_f32_16x16x32_bf16 v[40:43], v[140:143], v[136:139], 0
    ds_read_b128 v[172:175], v215 offset:2048
    v_mfma_f32_16x16x32_bf16 v[44:47], v[144:147], v[136:139], 0
    ds_read_b128 v[176:179], v215 offset:4096
    v_mfma_f32_16x16x32_bf16 v[36:39], v[144:147], v[132:135], 0
    ds_read_b128 v[180:183], v215 offset:6144
    v_mfma_f32_16x16x32_bf16 v[28:31], v[144:147], v[128:131], 0
    ds_read_b64_tr_b16 v[188:189], v219 offset:4096
    v_mfma_f32_16x16x32_bf16 v[20:23], v[144:147], v[124:127], 0
    ds_read_b64_tr_b16 v[190:191], v219 offset:4608
    v_mfma_f32_16x16x32_bf16 v[48:51], v[148:151], v[124:127], 0
    ds_read_b64_tr_b16 v[192:193], v218 offset:12288
    v_mfma_f32_16x16x32_bf16 v[56:59], v[148:151], v[128:131], 0
    ds_read_b64_tr_b16 v[194:195], v218 offset:12800
    v_mfma_f32_16x16x32_bf16 v[64:67], v[148:151], v[132:135], 0
    ds_read_b64_tr_b16 v[196:197], v219 offset:12288
    v_mfma_f32_16x16x32_bf16 v[72:75], v[148:151], v[136:139], 0
    ds_read_b64_tr_b16 v[198:199], v219 offset:12800
    v_mfma_f32_16x16x32_bf16 v[76:79], v[152:155], v[136:139], 0
    ds_read_b64_tr_b16 v[200:201], v218 offset:20480
    v_mfma_f32_16x16x32_bf16 v[68:71], v[152:155], v[132:135], 0
    ds_read_b64_tr_b16 v[202:203], v218 offset:20992
    v_mfma_f32_16x16x32_bf16 v[60:63], v[152:155], v[128:131], 0
    ds_read_b64_tr_b16 v[204:205], v219 offset:20480
    v_mfma_f32_16x16x32_bf16 v[52:55], v[152:155], v[124:127], 0
    ds_read_b64_tr_b16 v[206:207], v219 offset:20992
    v_mfma_f32_16x16x32_bf16 v[80:83], v[124:127], v[156:159], 0
    ds_read_b128 v[164:167], v217
    v_mfma_f32_16x16x32_bf16 v[88:91], v[128:131], v[156:159], 0
    v_add_u32 v214, s90, v208
    v_mfma_f32_16x16x32_bf16 v[96:99], v[132:135], v[156:159], 0
    v_add_u32 v216, s90, v210
    v_mfma_f32_16x16x32_bf16 v[104:107], v[136:139], v[156:159], 0
    v_add_u32 v218, s90, v212
    v_mfma_f32_16x16x32_bf16 v[108:111], v[136:139], v[160:163], 0
    v_add_u32 v219, s90, v213
    v_mfma_f32_16x16x32_bf16 v[100:103], v[132:135], v[160:163], 0
    v_mfma_f32_16x16x32_bf16 v[92:95], v[128:131], v[160:163], 0
    v_mfma_f32_16x16x32_bf16 v[84:87], v[124:127], v[160:163], 0
    v_mfma_f32_16x16x32_bf16 v[112:115], v[120:123], v[156:159], 0
    v_mfma_f32_16x16x32_bf16 v[116:119], v[120:123], v[160:163], 0
    s_lshr_b32 s81, s72, 1
    v_and_b32 v4, 1, v2
    v_lshl_add_u32 v5, v3, 2, v4
    v_add_u32 v6, 2, v5
    v_lshlrev_b32 v7, 1, v4
    v_cmp_le_u32 s[86:87], v5, v2
    v_cmp_le_u32 vcc, v6, v2
    v_add_u32 v8, 4, v7
    s_nop 0
    v_cndmask_b32 v5, v7, v8, s[86:87]
    v_cndmask_b32 v6, v7, v8, vcc
    s_mov_b32 s84, 0x01010000
    v_mul_lo_u32 v5, v5, s84
    v_add_u32 v220, 0x01000c0c, v5
    v_mul_lo_u32 v6, v6, s84
    v_add_u32 v221, 0x01000c0c, v6
    v_lshlrev_b32 v4, 4, v4
    v_mov_b32 v9, 0x0c0c0c0c
    v_mov_b32 v7, 0xc0c0100
    v_alignbit_b32 v7, v7, v7, v4
    v_cndmask_b32 v222, v7, v9, s[86:87]
    v_cndmask_b32 v224, v9, v7, s[86:87]
    v_mov_b32 v7, 0xc0c0302
    v_alignbit_b32 v7, v7, v7, v4
    v_cndmask_b32 v223, v7, v9, vcc
    v_cndmask_b32 v225, v9, v7, vcc
    s_or_b32 s84, s73, s81
    s_cmp_eq_u32 s84, 0
    s_cselect_b32 s84, 0xce6e6b28, 0
    v_mov_b32 v7, s84
    v_cndmask_b32 v226, v7, 0, s[86:87]
    v_cndmask_b32 v227, v7, 0, vcc
    s_waitcnt lgkmcnt(0)
    s_barrier
    s_branch qkv_4_in
.p2align 6
qkv_4:
    v_mfma_f32_16x16x32_bf16 v[84:87], v[124:127], v[160:163], v[84:87]
    s_barrier
    v_mfma_f32_16x16x32_bf16 v[112:115], v[120:123], v[156:159], v[112:115]
    v_mfma_f32_16x16x32_bf16 v[116:119], v[120:123], v[160:163], v[116:119]
qkv_4_in:
    v_mfma_f32_16x16x32_bf16 v[16:19], v[184:187], v[168:171], v[16:19]
    ds_read_b64_tr_b16 v[140:141], v218 offset:0
    v_mfma_f32_16x16x32_bf16 v[24:27], v[184:187], v[172:175], v[24:27]
    ds_read_b64_tr_b16 v[142:143], v218 offset:512
    v_mfma_f32_16x16x32_bf16 v[32:35], v[184:187], v[176:179], v[32:35]
    ds_read_b128 v[124:127], v214 offset:0
    v_mfma_f32_16x16x32_bf16 v[40:43], v[184:187], v[180:183], v[40:43]
    ds_read_b128 v[128:131], v214 offset:2048
    v_mfma_f32_16x16x32_bf16 v[44:47], v[188:191], v[180:183], v[44:47]
    ds_read_b128 v[132:135], v214 offset:4096
    v_mfma_f32_16x16x32_bf16 v[36:39], v[188:191], v[176:179], v[36:39]
    ds_read_b128 v[136:139], v214 offset:6144
    v_mfma_f32_16x16x32_bf16 v[28:31], v[188:191], v[172:175], v[28:31]
    ds_read_b64_tr_b16 v[144:145], v219 offset:0
    v_mfma_f32_16x16x32_bf16 v[20:23], v[188:191], v[168:171], v[20:23]
    ds_read_b64_tr_b16 v[146:147], v219 offset:512
    v_mfma_f32_16x16x32_bf16 v[48:51], v[192:195], v[168:171], v[48:51]
    ds_read_b64_tr_b16 v[148:149], v218 offset:8192
    v_mfma_f32_16x16x32_bf16 v[56:59], v[192:195], v[172:175], v[56:59]
    ds_read_b64_tr_b16 v[150:151], v218 offset:8704
    v_mfma_f32_16x16x32_bf16 v[64:67], v[192:195], v[176:179], v[64:67]
    ds_read_b64_tr_b16 v[152:153], v219 offset:8192
    v_mfma_f32_16x16x32_bf16 v[72:75], v[192:195], v[180:183], v[72:75]
    ds_read_b64_tr_b16 v[154:155], v219 offset:8704
    v_mfma_f32_16x16x32_bf16 v[76:79], v[196:199], v[180:183], v[76:79]
    ds_read_b64_tr_b16 v[156:157], v218 offset:16384
    v_mfma_f32_16x16x32_bf16 v[68:71], v[196:199], v[176:179], v[68:71]
    ds_read_b64_tr_b16 v[158:159], v218 offset:16896
    v_mfma_f32_16x16x32_bf16 v[60:63], v[196:199], v[172:175], v[60:63]
    ds_read_b64_tr_b16 v[160:161], v219 offset:16384
    v_mfma_f32_16x16x32_bf16 v[52:55], v[196:199], v[168:171], v[52:55]
    ds_read_b64_tr_b16 v[162:163], v219 offset:16896
    v_mfma_f32_16x16x32_bf16 v[80:83], v[168:171], v[200:203], v[80:83]
    ds_read_b128 v[120:123], v216
    v_mfma_f32_16x16x32_bf16 v[88:91], v[172:175], v[200:203], v[88:91]
    v_add_u32 v215, s90, v209
    v_mfma_f32_16x16x32_bf16 v[96:99], v[176:179], v[200:203], v[96:99]
    v_add_u32 v217, s90, v211
    v_mfma_f32_16x16x32_bf16 v[104:107], v[180:183], v[200:203], v[104:107]
    s_add_u32 s90, s90, 43008
    v_mfma_f32_16x16x32_bf16 v[108:111], v[180:183], v[204:207], v[108:111]
    s_cmp_eq_u32 s90, 129024
    v_mfma_f32_16x16x32_bf16 v[100:103], v[176:179], v[204:207], v[100:103]
    s_cselect_b32 s90, 0, s90
    v_mfma_f32_16x16x32_bf16 v[92:95], v[172:175], v[204:207], v[92:95]
    v_mfma_f32_16x16x32_bf16 v[84:87], v[168:171], v[204:207], v[84:87]
    v_mfma_f32_16x16x32_bf16 v[112:115], v[164:167], v[200:203], v[112:115]
    s_waitcnt lgkmcnt(0)
    v_mfma_f32_16x16x32_bf16 v[116:119], v[164:167], v[204:207], v[116:119]
    v_mfma_f32_16x16x32_bf16 v[16:19], v[140:143], v[124:127], v[16:19]
    ds_read_b64_tr_b16 v[184:185], v218 offset:4096
    v_mfma_f32_16x16x32_bf16 v[24:27], v[140:143], v[128:131], v[24:27]
    ds_read_b64_tr_b16 v[186:187], v218 offset:4608
    v_mfma_f32_16x16x32_bf16 v[32:35], v[140:143], v[132:135], v[32:35]
    ds_read_b128 v[168:171], v215 offset:0
    v_mfma_f32_16x16x32_bf16 v[40:43], v[140:143], v[136:139], v[40:43]
    ds_read_b128 v[172:175], v215 offset:2048
    v_mfma_f32_16x16x32_bf16 v[44:47], v[144:147], v[136:139], v[44:47]
    ds_read_b128 v[176:179], v215 offset:4096
    v_mfma_f32_16x16x32_bf16 v[36:39], v[144:147], v[132:135], v[36:39]
    ds_read_b128 v[180:183], v215 offset:6144
    v_mfma_f32_16x16x32_bf16 v[28:31], v[144:147], v[128:131], v[28:31]
    ds_read_b64_tr_b16 v[188:189], v219 offset:4096
    v_mfma_f32_16x16x32_bf16 v[20:23], v[144:147], v[124:127], v[20:23]
    ds_read_b64_tr_b16 v[190:191], v219 offset:4608
    v_mfma_f32_16x16x32_bf16 v[48:51], v[148:151], v[124:127], v[48:51]
    ds_read_b64_tr_b16 v[192:193], v218 offset:12288
    v_mfma_f32_16x16x32_bf16 v[56:59], v[148:151], v[128:131], v[56:59]
    ds_read_b64_tr_b16 v[194:195], v218 offset:12800
    v_mfma_f32_16x16x32_bf16 v[64:67], v[148:151], v[132:135], v[64:67]
    ds_read_b64_tr_b16 v[196:197], v219 offset:12288
    v_mfma_f32_16x16x32_bf16 v[72:75], v[148:151], v[136:139], v[72:75]
    ds_read_b64_tr_b16 v[198:199], v219 offset:12800
    v_mfma_f32_16x16x32_bf16 v[76:79], v[152:155], v[136:139], v[76:79]
    ds_read_b64_tr_b16 v[200:201], v218 offset:20480
    v_mfma_f32_16x16x32_bf16 v[68:71], v[152:155], v[132:135], v[68:71]
    ds_read_b64_tr_b16 v[202:203], v218 offset:20992
    v_mfma_f32_16x16x32_bf16 v[60:63], v[152:155], v[128:131], v[60:63]
    ds_read_b64_tr_b16 v[204:205], v219 offset:20480
    v_mfma_f32_16x16x32_bf16 v[52:55], v[152:155], v[124:127], v[52:55]
    ds_read_b64_tr_b16 v[206:207], v219 offset:20992
    v_mfma_f32_16x16x32_bf16 v[80:83], v[124:127], v[156:159], v[80:83]
    ds_read_b128 v[164:167], v217
    v_mfma_f32_16x16x32_bf16 v[88:91], v[128:131], v[156:159], v[88:91]
    v_add_u32 v214, s90, v208
    v_mfma_f32_16x16x32_bf16 v[96:99], v[132:135], v[156:159], v[96:99]
    v_add_u32 v216, s90, v210
    v_mfma_f32_16x16x32_bf16 v[104:107], v[136:139], v[156:159], v[104:107]
    v_add_u32 v218, s90, v212
    v_mfma_f32_16x16x32_bf16 v[108:111], v[136:139], v[160:163], v[108:111]
    v_add_u32 v219, s90, v213
    v_mfma_f32_16x16x32_bf16 v[100:103], v[132:135], v[160:163], v[100:103]
    s_add_u32 s89, s89, 1
    s_cmp_lt_u32 s89, 15
    s_waitcnt lgkmcnt(0)
    v_mfma_f32_16x16x32_bf16 v[92:95], v[128:131], v[160:163], v[92:95]
    s_cbranch_scc1 qkv_4
    v_mfma_f32_16x16x32_bf16 v[84:87], v[124:127], v[160:163], v[84:87]
    v_mfma_f32_16x16x32_bf16 v[112:115], v[120:123], v[156:159], v[112:115]
    v_mfma_f32_16x16x32_bf16 v[116:119], v[120:123], v[160:163], v[116:119]
    v_mfma_f32_16x16x32_bf16 v[16:19], v[184:187], v[168:171], v[16:19]
    v_mfma_f32_16x16x32_bf16 v[24:27], v[184:187], v[172:175], v[24:27]
    v_mfma_f32_16x16x32_bf16 v[32:35], v[184:187], v[176:179], v[32:35]
    v_mfma_f32_16x16x32_bf16 v[40:43], v[184:187], v[180:183], v[40:43]
    v_mfma_f32_16x16x32_bf16 v[44:47], v[188:191], v[180:183], v[44:47]
    v_mfma_f32_16x16x32_bf16 v[36:39], v[188:191], v[176:179], v[36:39]
    v_mfma_f32_16x16x32_bf16 v[28:31], v[188:191], v[172:175], v[28:31]
    v_mfma_f32_16x16x32_bf16 v[20:23], v[188:191], v[168:171], v[20:23]
    v_mfma_f32_16x16x32_bf16 v[48:51], v[192:195], v[168:171], v[48:51]
    v_mfma_f32_16x16x32_bf16 v[56:59], v[192:195], v[172:175], v[56:59]
    v_mfma_f32_16x16x32_bf16 v[64:67], v[192:195], v[176:179], v[64:67]
    v_mfma_f32_16x16x32_bf16 v[72:75], v[192:195], v[180:183], v[72:75]
    v_mfma_f32_16x16x32_bf16 v[76:79], v[196:199], v[180:183], v[76:79]
    v_mfma_f32_16x16x32_bf16 v[68:71], v[196:199], v[176:179], v[68:71]
    v_mfma_f32_16x16x32_bf16 v[60:63], v[196:199], v[172:175], v[60:63]
    v_mfma_f32_16x16x32_bf16 v[52:55], v[196:199], v[168:171], v[52:55]
    v_mfma_f32_16x16x32_bf16 v[80:83], v[168:171], v[200:203], v[80:83]
    v_mfma_f32_16x16x32_bf16 v[88:91], v[172:175], v[200:203], v[88:91]
    v_mfma_f32_16x16x32_bf16 v[96:99], v[176:179], v[200:203], v[96:99]
    v_mfma_f32_16x16x32_bf16 v[104:107], v[180:183], v[200:203], v[104:107]
    v_mfma_f32_16x16x32_bf16 v[108:111], v[180:183], v[204:207], v[108:111]
    v_mfma_f32_16x16x32_bf16 v[100:103], v[176:179], v[204:207], v[100:103]
    v_mfma_f32_16x16x32_bf16 v[92:95], v[172:175], v[204:207], v[92:95]
    v_mfma_f32_16x16x32_bf16 v[84:87], v[168:171], v[204:207], v[84:87]
    v_mfma_f32_16x16x32_bf16 v[112:115], v[164:167], v[200:203], v[112:115]
    v_mfma_f32_16x16x32_bf16 v[116:119], v[164:167], v[204:207], v[116:119]
    s_and_b32 s82, s72, 1
    s_mul_i32 s82, s82, 3072
    s_add_u32 s82, s82, 149504
    v_lshlrev_b32 v15, 4, v1
    v_add_u32 v14, s82, v15
    s_and_b32 s82, s72, 1
    s_lshl_b32 s82, s82, 2
    s_add_u32 s82, s82, 155656
    v_mov_b32 v13, s82
    v_cvt_pk_bf16_f32 v192, v112, v113
    v_cvt_pk_bf16_f32 v193, v114, v115
    v_cvt_pk_bf16_f32 v194, v116, v117
    v_cvt_pk_bf16_f32 v195, v118, v119
    ds_write_b128 v14, v[192:195] offset:2048
    v_mov_b32 v5, 1
    s_mov_b64 exec, 1
    ds_add_u32 v13, v5
    s_mov_b64 exec, -1
    v_cvt_pk_bf16_f32 v120, v16, v17
    v_cvt_pk_bf16_f32 v121, v18, v19
    v_cvt_pk_bf16_f32 v122, v20, v21
    v_cvt_pk_bf16_f32 v123, v22, v23
    v_cvt_pk_bf16_f32 v124, v24, v25
    v_cvt_pk_bf16_f32 v125, v26, v27
    v_cvt_pk_bf16_f32 v126, v28, v29
    v_cvt_pk_bf16_f32 v127, v30, v31
    v_cvt_pk_bf16_f32 v128, v32, v33
    v_cvt_pk_bf16_f32 v129, v34, v35
    v_cvt_pk_bf16_f32 v130, v36, v37
    v_cvt_pk_bf16_f32 v131, v38, v39
    v_cvt_pk_bf16_f32 v132, v40, v41
    v_cvt_pk_bf16_f32 v133, v42, v43
    v_cvt_pk_bf16_f32 v134, v44, v45
    v_cvt_pk_bf16_f32 v135, v46, v47
    v_cvt_pk_bf16_f32 v140, v48, v49
    v_cvt_pk_bf16_f32 v141, v50, v51
    v_cvt_pk_bf16_f32 v142, v52, v53
    v_cvt_pk_bf16_f32 v143, v54, v55
    v_cvt_pk_bf16_f32 v144, v56, v57
    v_cvt_pk_bf16_f32 v145, v58, v59
    v_cvt_pk_bf16_f32 v146, v60, v61
    v_cvt_pk_bf16_f32 v147, v62, v63
    v_cvt_pk_bf16_f32 v148, v64, v65
    v_cvt_pk_bf16_f32 v149, v66, v67
    v_cvt_pk_bf16_f32 v150, v68, v69
    v_cvt_pk_bf16_f32 v151, v70, v71
    v_cvt_pk_bf16_f32 v152, v72, v73
    v_cvt_pk_bf16_f32 v153, v74, v75
    v_cvt_pk_bf16_f32 v154, v76, v77
    v_cvt_pk_bf16_f32 v155, v78, v79
ex_5:
    ds_read_b32 v6, v13
    ds_read_b128 v[136:139], v14
    ds_read_b64 v[156:157], v14 offset:1024
    ds_read_b64 v[166:167], v14 offset:1032
    v_mfma_f32_16x16x32_bf16 v[44:47], v[152:155], v[132:135], 0
    v_mfma_f32_16x16x32_bf16 v[40:43], v[148:151], v[132:135], 0
    v_mfma_f32_16x16x32_bf16 v[36:39], v[148:151], v[128:131], 0
    v_mfma_f32_16x16x32_bf16 v[32:35], v[144:147], v[128:131], 0
    v_mfma_f32_16x16x32_bf16 v[28:31], v[144:147], v[124:127], 0
    v_mfma_f32_16x16x32_bf16 v[24:27], v[140:143], v[124:127], 0
    v_mfma_f32_16x16x32_bf16 v[20:23], v[140:143], v[120:123], 0
    s_waitcnt lgkmcnt(0)
    v_readfirstlane_b32 s81, v6
    s_nop 1
    s_cmp_lt_u32 s81, 2
    s_cbranch_scc1 ex_5
    v_mfma_f32_16x16x32_bf16 v[16:19], v[136:139], v[120:123], 0
    s_mov_b32 s83, 0x3e3504f3
    s_mov_b32 s84, 0x3fb8aa3b
    s_mov_b32 s85, 0xbfb8aa3b
    v_cvt_pk_bf16_f32 v188, v40, v41
    v_cvt_pk_bf16_f32 v189, v42, v43
    v_cvt_pk_bf16_f32 v190, v44, v45
    v_cvt_pk_bf16_f32 v191, v46, v47
    v_cvt_pk_bf16_f32 v184, v32, v33
    v_cvt_pk_bf16_f32 v185, v34, v35
    v_cvt_pk_bf16_f32 v186, v36, v37
    v_cvt_pk_bf16_f32 v187, v38, v39
    v_cvt_pk_bf16_f32 v180, v24, v25
    v_cvt_pk_bf16_f32 v181, v26, v27
    v_cvt_pk_bf16_f32 v182, v28, v29
    v_cvt_pk_bf16_f32 v183, v30, v31
    v_cvt_pk_bf16_f32 v176, v16, v17
    v_cvt_pk_bf16_f32 v177, v18, v19
    v_cvt_pk_bf16_f32 v178, v20, v21
    v_cvt_pk_bf16_f32 v179, v22, v23
    v_perm_b32 v198, v190, v188, v220
    v_perm_b32 v199, v191, v189, v221
    v_perm_b32 v196, v186, v184, v220
    v_perm_b32 v197, v187, v185, v221
    v_perm_b32 v194, v182, v180, v220
    v_perm_b32 v195, v183, v181, v221
    v_perm_b32 v192, v178, v176, v220
    v_perm_b32 v193, v179, v177, v221
    v_mul_f32 v198, s83, v198
    v_mul_f32 v199, s83, v199
    v_mul_f32 v196, s83, v196
    v_mul_f32 v197, s83, v197
    v_mul_f32 v194, s83, v194
    v_mul_f32 v195, s83, v195
    v_fma_f32 v192, v192, s83, v226
    v_fma_f32 v193, v193, s83, v227
    v_cvt_pk_bf16_f32 v203, v198, v199
    v_cvt_pk_bf16_f32 v202, v196, v197
    v_cvt_pk_bf16_f32 v201, v194, v195
    v_cvt_pk_bf16_f32 v200, v192, v193
    v_lshlrev_b32 v198, 16, v203
    v_and_b32 v199, 0xffff0000, v203
    v_lshlrev_b32 v196, 16, v202
    v_and_b32 v197, 0xffff0000, v202
    v_lshlrev_b32 v194, 16, v201
    v_and_b32 v195, 0xffff0000, v201
    v_lshlrev_b32 v192, 16, v200
    v_and_b32 v193, 0xffff0000, v200
    v_max_f32 v203, v198, v199
    v_max_f32 v202, v196, v197
    v_max_f32 v201, v194, v195
    v_max_f32 v200, v192, v193
    s_nop 1
    v_permlane16_swap_b32 v200, v201
    v_cvt_pk_bf16_f32 v158, v80, v81
    v_permlane16_swap_b32 v202, v203
    v_cvt_pk_bf16_f32 v159, v82, v83
    v_max_f32 v200, v200, v201
    v_cvt_pk_bf16_f32 v168, v84, v85
    v_max_f32 v202, v202, v203
    v_cvt_pk_bf16_f32 v169, v86, v87
    s_nop 0
    v_permlane32_swap_b32 v200, v202
    v_cvt_pk_bf16_f32 v160, v88, v89
    v_max_f32 v200, v200, v202
    v_cvt_pk_bf16_f32 v161, v90, v91
    v_mul_f32 v200, s85, v200
    v_mov_b32 v202, v200
    v_cvt_pk_bf16_f32 v170, v92, v93
    s_nop 0
    v_permlane32_swap_b32 v200, v202
    v_cvt_pk_bf16_f32 v171, v94, v95
    v_mov_b32 v201, v200
    v_cvt_pk_bf16_f32 v162, v96, v97
    v_mov_b32 v203, v202
    v_cvt_pk_bf16_f32 v163, v98, v99
    v_permlane16_swap_b32 v200, v201
    v_cvt_pk_bf16_f32 v172, v100, v101
    v_permlane16_swap_b32 v202, v203
    v_cvt_pk_bf16_f32 v173, v102, v103
    v_fma_f32 v198, v198, s84, v203
    v_fma_f32 v199, v199, s84, v203
    v_fma_f32 v196, v196, s84, v202
    v_fma_f32 v197, v197, s84, v202
    v_fma_f32 v194, v194, s84, v201
    v_fma_f32 v195, v195, s84, v201
    v_fma_f32 v192, v192, s84, v200
    v_fma_f32 v193, v193, s84, v200
    v_exp_f32 v199, v199
    v_exp_f32 v198, v198
    v_exp_f32 v197, v197
    v_exp_f32 v196, v196
    v_exp_f32 v195, v195
    v_exp_f32 v194, v194
    v_exp_f32 v193, v193
    v_exp_f32 v192, v192
    v_add_f32 v203, v198, v199
    v_add_f32 v202, v196, v197
    v_add_f32 v201, v194, v195
    v_add_f32 v200, v192, v193
    s_nop 1
    v_permlane16_swap_b32 v200, v201
    v_cvt_pk_bf16_f32 v164, v104, v105
    v_permlane16_swap_b32 v202, v203
    v_cvt_pk_bf16_f32 v165, v106, v107
    v_add_f32 v200, v200, v201
    v_cvt_pk_bf16_f32 v174, v108, v109
    v_add_f32 v202, v202, v203
    v_cvt_pk_bf16_f32 v175, v110, v111
    s_nop 0
    v_permlane32_swap_b32 v200, v202
    v_add_f32 v200, v200, v202
    v_rcp_f32 v200, v200
    s_nop 0
    v_mov_b32 v202, v200
    s_nop 1
    v_permlane32_swap_b32 v200, v202
    v_mov_b32 v201, v200
    v_mov_b32 v203, v202
    s_nop 0
    v_permlane16_swap_b32 v200, v201
    v_permlane16_swap_b32 v202, v203
    v_mul_f32 v198, v198, v203
    v_mul_f32 v199, v199, v203
    v_mul_f32 v196, v196, v202
    v_mul_f32 v197, v197, v202
    v_mul_f32 v194, v194, v201
    v_mul_f32 v195, v195, v201
    v_mul_f32 v192, v192, v200
    v_mul_f32 v193, v193, v200
    v_cvt_pk_bf16_f32 v203, v198, v199
    v_cvt_pk_bf16_f32 v202, v196, v197
    v_cvt_pk_bf16_f32 v201, v194, v195
    v_cvt_pk_bf16_f32 v200, v192, v193
    v_perm_b32 v188, v203, v203, v222
    v_perm_b32 v189, v203, v203, v223
    v_perm_b32 v190, v203, v203, v224
    v_perm_b32 v191, v203, v203, v225
    v_perm_b32 v184, v202, v202, v222
    v_perm_b32 v185, v202, v202, v223
    v_perm_b32 v186, v202, v202, v224
    v_perm_b32 v187, v202, v202, v225
    v_perm_b32 v180, v201, v201, v222
    v_perm_b32 v181, v201, v201, v223
    v_perm_b32 v182, v201, v201, v224
    v_perm_b32 v183, v201, v201, v225
    v_perm_b32 v176, v200, v200, v222
    v_perm_b32 v177, v200, v200, v223
    v_perm_b32 v178, v200, v200, v224
    v_perm_b32 v179, v200, v200, v225
    s_lshl_b32 s81, s73, 3
    s_add_u32 s81, s81, 4
    s_lshl_b32 s81, s81, 5
    s_lshl_b32 s82, s74, 1
    s_add_u32 s81, s81, s82
    s_and_b32 s82, s72, 1
    s_add_u32 s81, s81, s82
    s_lshl_b32 s81, s81, 10
    v_mfma_f32_16x16x32_bf16 v[72:75], v[162:165], v[188:191], 0
    v_mfma_f32_16x16x32_bf16 v[76:79], v[172:175], v[188:191], 0
    v_mfma_f32_16x16x32_bf16 v[64:67], v[160:163], v[184:187], 0
    v_mfma_f32_16x16x32_bf16 v[68:71], v[170:173], v[184:187], 0
    v_mfma_f32_16x16x32_bf16 v[56:59], v[158:161], v[180:183], 0
    v_mfma_f32_16x16x32_bf16 v[60:63], v[168:171], v[180:183], 0
    v_mfma_f32_16x16x32_bf16 v[48:51], v[156:159], v[176:179], 0
    v_mfma_f32_16x16x32_bf16 v[52:55], v[166:169], v[176:179], 0
    s_nop 0
    v_cvt_pk_bf16_f32 v92, v72, v73
    v_cvt_pk_bf16_f32 v93, v74, v75
    v_cvt_pk_bf16_f32 v94, v76, v77
    v_cvt_pk_bf16_f32 v95, v78, v79
    s_add_u32 s82, s81, 98304
    buffer_store_dwordx4 v[92:95], v15, s[64:67], s82 offen sc1
    v_cvt_pk_bf16_f32 v88, v64, v65
    v_cvt_pk_bf16_f32 v89, v66, v67
    v_cvt_pk_bf16_f32 v90, v68, v69
    v_cvt_pk_bf16_f32 v91, v70, v71
    s_add_u32 s82, s81, 65536
    buffer_store_dwordx4 v[88:91], v15, s[64:67], s82 offen sc1
    v_cvt_pk_bf16_f32 v84, v56, v57
    v_cvt_pk_bf16_f32 v85, v58, v59
    v_cvt_pk_bf16_f32 v86, v60, v61
    v_cvt_pk_bf16_f32 v87, v62, v63
    s_add_u32 s82, s81, 32768
    buffer_store_dwordx4 v[84:87], v15, s[64:67], s82 offen sc1
    v_cvt_pk_bf16_f32 v80, v48, v49
    v_cvt_pk_bf16_f32 v81, v50, v51
    v_cvt_pk_bf16_f32 v82, v52, v53
    v_cvt_pk_bf16_f32 v83, v54, v55
    s_add_u32 s82, s81, 0
    buffer_store_dwordx4 v[80:83], v15, s[64:67], s82 offen sc1
    v_mov_b32 v4, 155664
    v_mov_b32 v5, 1
    s_mov_b64 exec, 1
    ds_add_u32 v4, v5
    s_mov_b64 exec, -1
L_cj:
    s_lshl_b32 s87, s72, 8
    s_add_u32 s87, s87, s16
    v_lshl_add_u32 v14, v2, 4, s87
    v_cvt_f32_u32 v14, v14
    v_mul_f32 v14, 0x3a000000, v14
    v_lshlrev_b32 v15, 3, v3
    v_cvt_f32_u32 v15, v15
    v_mul_f32 v15, v15, v14
    v_mul_f32 v8, 0x42000000, v14
    v_cos_f32 v212, v8
    v_sin_f32 v214, v8
    v_cos_f32 v192, v15
    v_sin_f32 v200, v15
    v_add_f32 v15, v15, v14
    v_cos_f32 v193, v15
    v_sin_f32 v201, v15
    v_add_f32 v15, v15, v14
    v_cos_f32 v194, v15
    v_sin_f32 v202, v15
    v_add_f32 v15, v15, v14
    v_cos_f32 v195, v15
    v_sin_f32 v203, v15
    v_add_f32 v15, v15, v14
    v_cos_f32 v196, v15
    v_sin_f32 v204, v15
    v_add_f32 v15, v15, v14
    v_cos_f32 v197, v15
    v_sin_f32 v205, v15
    v_add_f32 v15, v15, v14
    v_cos_f32 v198, v15
    v_sin_f32 v206, v15
    v_add_f32 v15, v15, v14
    v_cos_f32 v199, v15
    v_sin_f32 v207, v15
    v_cvt_pk_bf16_f32 v144, v192, v193
    v_cvt_pk_bf16_f32 v160, -v200, -v201
    v_cvt_pk_bf16_f32 v145, v194, v195
    v_cvt_pk_bf16_f32 v161, -v202, -v203
    v_cvt_pk_bf16_f32 v146, v196, v197
    v_cvt_pk_bf16_f32 v162, -v204, -v205
    v_cvt_pk_bf16_f32 v147, v198, v199
    v_cvt_pk_bf16_f32 v163, -v206, -v207
    v_pk_mul_f32 v[208:209], v[192:193], v[212:213] op_sel_hi:[1,0]
    v_pk_mul_f32 v[210:211], v[192:193], v[214:215] op_sel_hi:[1,0]
    v_pk_fma_f32 v[192:193], v[200:201], v[214:215], v[208:209] op_sel_hi:[1,0,1] neg_lo:[1,0,0] neg_hi:[1,0,0]
    v_pk_fma_f32 v[200:201], v[200:201], v[212:213], v[210:211] op_sel_hi:[1,0,1]
    v_pk_mul_f32 v[208:209], v[194:195], v[212:213] op_sel_hi:[1,0]
    v_pk_mul_f32 v[210:211], v[194:195], v[214:215] op_sel_hi:[1,0]
    v_pk_fma_f32 v[194:195], v[202:203], v[214:215], v[208:209] op_sel_hi:[1,0,1] neg_lo:[1,0,0] neg_hi:[1,0,0]
    v_pk_fma_f32 v[202:203], v[202:203], v[212:213], v[210:211] op_sel_hi:[1,0,1]
    v_pk_mul_f32 v[208:209], v[196:197], v[212:213] op_sel_hi:[1,0]
    v_pk_mul_f32 v[210:211], v[196:197], v[214:215] op_sel_hi:[1,0]
    v_pk_fma_f32 v[196:197], v[204:205], v[214:215], v[208:209] op_sel_hi:[1,0,1] neg_lo:[1,0,0] neg_hi:[1,0,0]
    v_pk_fma_f32 v[204:205], v[204:205], v[212:213], v[210:211] op_sel_hi:[1,0,1]
    v_pk_mul_f32 v[208:209], v[198:199], v[212:213] op_sel_hi:[1,0]
    v_pk_mul_f32 v[210:211], v[198:199], v[214:215] op_sel_hi:[1,0]
    v_pk_fma_f32 v[198:199], v[206:207], v[214:215], v[208:209] op_sel_hi:[1,0,1] neg_lo:[1,0,0] neg_hi:[1,0,0]
    v_pk_fma_f32 v[206:207], v[206:207], v[212:213], v[210:211] op_sel_hi:[1,0,1]
    v_cvt_pk_bf16_f32 v148, v192, v193
    v_cvt_pk_bf16_f32 v164, -v200, -v201
    v_cvt_pk_bf16_f32 v149, v194, v195
    v_cvt_pk_bf16_f32 v165, -v202, -v203
    v_cvt_pk_bf16_f32 v150, v196, v197
    v_cvt_pk_bf16_f32 v166, -v204, -v205
    v_cvt_pk_bf16_f32 v151, v198, v199
    v_cvt_pk_bf16_f32 v167, -v206, -v207
    s_lshl_b32 s81, s73, 4
    s_add_u32 s81, s81, s74
    s_lshl_b32 s81, s81, 2
    s_add_u32 s81, s81, s72
    s_lshl_b32 s81, s81, 6
    s_add_u32 s81, s81, 9437184
    v_mov_b32 v4, 1
    v_mov_b32 v5, 1
    v_mov_b32 v6, 1
    v_mov_b32 v7, 1
    v_lshlrev_b32 v9, 4, v1
    s_mov_b64 exec, 15
    s_waitcnt vmcnt(0)
    buffer_store_dwordx4 v[4:7], v9, s[64:67], s81 offen sc1
    s_mov_b64 exec, -1
    v_pk_mul_f32 v[208:209], v[192:193], v[212:213] op_sel_hi:[1,0]
    v_pk_mul_f32 v[210:211], v[192:193], v[214:215] op_sel_hi:[1,0]
    v_pk_fma_f32 v[192:193], v[200:201], v[214:215], v[208:209] op_sel_hi:[1,0,1] neg_lo:[1,0,0] neg_hi:[1,0,0]
    v_pk_fma_f32 v[200:201], v[200:201], v[212:213], v[210:211] op_sel_hi:[1,0,1]
    v_pk_mul_f32 v[208:209], v[194:195], v[212:213] op_sel_hi:[1,0]
    v_pk_mul_f32 v[210:211], v[194:195], v[214:215] op_sel_hi:[1,0]
    v_pk_fma_f32 v[194:195], v[202:203], v[214:215], v[208:209] op_sel_hi:[1,0,1] neg_lo:[1,0,0] neg_hi:[1,0,0]
    v_pk_fma_f32 v[202:203], v[202:203], v[212:213], v[210:211] op_sel_hi:[1,0,1]
    v_pk_mul_f32 v[208:209], v[196:197], v[212:213] op_sel_hi:[1,0]
    v_pk_mul_f32 v[210:211], v[196:197], v[214:215] op_sel_hi:[1,0]
    v_pk_fma_f32 v[196:197], v[204:205], v[214:215], v[208:209] op_sel_hi:[1,0,1] neg_lo:[1,0,0] neg_hi:[1,0,0]
    v_pk_fma_f32 v[204:205], v[204:205], v[212:213], v[210:211] op_sel_hi:[1,0,1]
    v_pk_mul_f32 v[208:209], v[198:199], v[212:213] op_sel_hi:[1,0]
    v_pk_mul_f32 v[210:211], v[198:199], v[214:215] op_sel_hi:[1,0]
    v_pk_fma_f32 v[198:199], v[206:207], v[214:215], v[208:209] op_sel_hi:[1,0,1] neg_lo:[1,0,0] neg_hi:[1,0,0]
    v_pk_fma_f32 v[206:207], v[206:207], v[212:213], v[210:211] op_sel_hi:[1,0,1]
    v_cvt_pk_bf16_f32 v152, v192, v193
    v_cvt_pk_bf16_f32 v168, -v200, -v201
    v_cvt_pk_bf16_f32 v153, v194, v195
    v_cvt_pk_bf16_f32 v169, -v202, -v203
    v_cvt_pk_bf16_f32 v154, v196, v197
    v_cvt_pk_bf16_f32 v170, -v204, -v205
    v_cvt_pk_bf16_f32 v155, v198, v199
    v_cvt_pk_bf16_f32 v171, -v206, -v207
    v_pk_mul_f32 v[208:209], v[192:193], v[212:213] op_sel_hi:[1,0]
    v_pk_mul_f32 v[210:211], v[192:193], v[214:215] op_sel_hi:[1,0]
    v_pk_fma_f32 v[192:193], v[200:201], v[214:215], v[208:209] op_sel_hi:[1,0,1] neg_lo:[1,0,0] neg_hi:[1,0,0]
    v_pk_fma_f32 v[200:201], v[200:201], v[212:213], v[210:211] op_sel_hi:[1,0,1]
    v_pk_mul_f32 v[208:209], v[194:195], v[212:213] op_sel_hi:[1,0]
    v_pk_mul_f32 v[210:211], v[194:195], v[214:215] op_sel_hi:[1,0]
    v_pk_fma_f32 v[194:195], v[202:203], v[214:215], v[208:209] op_sel_hi:[1,0,1] neg_lo:[1,0,0] neg_hi:[1,0,0]
    v_pk_fma_f32 v[202:203], v[202:203], v[212:213], v[210:211] op_sel_hi:[1,0,1]
    v_pk_mul_f32 v[208:209], v[196:197], v[212:213] op_sel_hi:[1,0]
    v_pk_mul_f32 v[210:211], v[196:197], v[214:215] op_sel_hi:[1,0]
    v_pk_fma_f32 v[196:197], v[204:205], v[214:215], v[208:209] op_sel_hi:[1,0,1] neg_lo:[1,0,0] neg_hi:[1,0,0]
    v_pk_fma_f32 v[204:205], v[204:205], v[212:213], v[210:211] op_sel_hi:[1,0,1]
    v_pk_mul_f32 v[208:209], v[198:199], v[212:213] op_sel_hi:[1,0]
    v_pk_mul_f32 v[210:211], v[198:199], v[214:215] op_sel_hi:[1,0]
    v_pk_fma_f32 v[198:199], v[206:207], v[214:215], v[208:209] op_sel_hi:[1,0,1] neg_lo:[1,0,0] neg_hi:[1,0,0]
    v_pk_fma_f32 v[206:207], v[206:207], v[212:213], v[210:211] op_sel_hi:[1,0,1]
    v_cvt_pk_bf16_f32 v156, v192, v193
    v_cvt_pk_bf16_f32 v172, -v200, -v201
    v_cvt_pk_bf16_f32 v157, v194, v195
    v_cvt_pk_bf16_f32 v173, -v202, -v203
    v_cvt_pk_bf16_f32 v158, v196, v197
    v_cvt_pk_bf16_f32 v174, -v204, -v205
    v_cvt_pk_bf16_f32 v159, v198, v199
    v_cvt_pk_bf16_f32 v175, -v206, -v207
    v_lshrrev_b32 v4, 3, v2
    v_and_b32 v5, 1, v3
    v_lshl_add_u32 v4, v5, 1, v4
    v_lshlrev_b32 v4, 5, v4
    v_and_b32 v5, 3, v2
    v_lshl_add_u32 v4, v5, 3, v4
    v_lshrrev_b32 v5, 2, v2
    v_lshl_add_u32 v5, v3, 2, v5
    v_lshl_add_u32 v4, v5, 7, v4
    s_lshr_b32 s82, s72, 2
    s_lshl_b32 s83, s82, 16
    v_add_u32 v228, s83, v4
    v_xor_b32 v229, 32, v228
    v_xor_b32 v230, 64, v228
    v_xor_b32 v231, 96, v228
    s_and_b32 s81, s72, 3
    s_lshl_b32 s81, s81, 1
    s_lshl_b32 s83, s75, 3
    s_add_u32 s81, s81, s83
    s_lshl_b32 s81, s81, 15
    s_lshl_b32 s82, s82, 14
    s_add_u32 s95, s81, s82
    v_lshlrev_b32 v232, 4, v1
    v_add_u32 v233, 0x8000, v232
    s_mov_b32 s93, s80
    v_lshrrev_b32 v10, 2, v2
    v_lshl_add_u32 v10, v3, 3, v10
    v_and_b32 v9, 1, v3
    v_lshlrev_b32 v9, 3, v9
    v_lshl_add_u32 v12, v10, 4, v9
    v_add_u32 v240, 147456, v12
    v_xor_b32 v241, 8, v240
    v_lshl_add_u32 v10, v10, 7, v9
    v_and_b32 v11, 3, v2
    v_lshl_add_u32 v10, v11, 5, v10
    v_lshrrev_b32 v11, 3, v2
    v_lshl_add_u32 v10, v11, 4, v10
    v_add_u32 v236, 131072, v10
    v_xor_b32 v237, 8, v236
    v_xor_b32 v238, 16, v236
    v_xor_b32 v239, 24, v236
    s_lshl_b32 s81, s72, 8
    s_add_u32 s81, s81, s16
    v_lshl_add_u32 v14, v2, 4, s81
    v_lshlrev_b32 v6, 4, v3
    s_lshl_b32 s81, s17, 6
    s_add_u32 s85, s81, 2048
    s_sub_u32 s83, 4080, s81
    v_sub_u32 v8, 2048, v14
    v_and_b32 v8, 2047, v8
    v_lshlrev_b32 v8, 12, v8
    v_sub_u32 v8, v8, v6
    v_add_u32 v184, s83, v8
    v_lshl_add_u32 v14, v14, 12, v6
    v_add_u32 v185, s85, v14
    v_add_u32 v9, 16, v1
    v_lshlrev_b32 v186, 2, v9
    v_mov_b32 v4, 155652
lw_7:
    ds_read_b32 v6, v4
    s_waitcnt lgkmcnt(0)
    v_readfirstlane_b32 s81, v6
    s_nop 1
    s_cmp_lt_u32 s81, 2
    s_cbranch_scc1 lw_7
    ds_read_b64_tr_b16 v[192:193], v236 offset:0
    ds_read_b64_tr_b16 v[194:195], v236 offset:512
    ds_read_b64_tr_b16 v[196:197], v238 offset:0
    ds_read_b64_tr_b16 v[198:199], v238 offset:512
    ds_read_b64_tr_b16 v[200:201], v240 offset:0
    ds_read_b64_tr_b16 v[202:203], v240 offset:64
    ds_read_b64_tr_b16 v[204:205], v236 offset:4096
    ds_read_b64_tr_b16 v[206:207], v236 offset:4608
    ds_read_b64_tr_b16 v[208:209], v238 offset:4096
    ds_read_b64_tr_b16 v[210:211], v238 offset:4608
    ds_read_b64_tr_b16 v[212:213], v240 offset:512
    ds_read_b64_tr_b16 v[214:215], v240 offset:576
    ds_read_b64_tr_b16 v[216:217], v236 offset:8192
    ds_read_b64_tr_b16 v[218:219], v236 offset:8704
    ds_read_b64_tr_b16 v[220:221], v238 offset:8192
    ds_read_b64_tr_b16 v[222:223], v238 offset:8704
    ds_read_b64_tr_b16 v[224:225], v240 offset:1024
    ds_read_b64_tr_b16 v[226:227], v240 offset:1088
    s_waitcnt lgkmcnt(12)
    v_mfma_f32_16x16x32_bf16 v[80:83], v[192:195], v[144:147], 0
    v_mfma_f32_16x16x32_bf16 v[84:87], v[196:199], v[144:147], 0
    v_mfma_f32_16x16x32_bf16 v[88:91], v[200:203], v[144:147], 0
    ds_read_b64_tr_b16 v[192:193], v236 offset:12288
    ds_read_b64_tr_b16 v[194:195], v236 offset:12800
    ds_read_b64_tr_b16 v[196:197], v238 offset:12288
    ds_read_b64_tr_b16 v[198:199], v238 offset:12800
    ds_read_b64_tr_b16 v[200:201], v240 offset:1536
    ds_read_b64_tr_b16 v[202:203], v240 offset:1600
    s_waitcnt lgkmcnt(12)
    v_mfma_f32_16x16x32_bf16 v[80:83], v[204:207], v[148:151], v[80:83]
    v_mfma_f32_16x16x32_bf16 v[84:87], v[208:211], v[148:151], v[84:87]
    v_mfma_f32_16x16x32_bf16 v[88:91], v[212:215], v[148:151], v[88:91]
    ds_read_b64_tr_b16 v[204:205], v237 offset:0
    ds_read_b64_tr_b16 v[206:207], v237 offset:512
    ds_read_b64_tr_b16 v[208:209], v239 offset:0
    ds_read_b64_tr_b16 v[210:211], v239 offset:512
    ds_read_b64_tr_b16 v[212:213], v241 offset:0
    ds_read_b64_tr_b16 v[214:215], v241 offset:64
    s_waitcnt lgkmcnt(12)
    v_mfma_f32_16x16x32_bf16 v[80:83], v[216:219], v[152:155], v[80:83]
    v_mfma_f32_16x16x32_bf16 v[84:87], v[220:223], v[152:155], v[84:87]
    v_mfma_f32_16x16x32_bf16 v[88:91], v[224:227], v[152:155], v[88:91]
    ds_read_b64_tr_b16 v[216:217], v237 offset:4096
    ds_read_b64_tr_b16 v[218:219], v237 offset:4608
    ds_read_b64_tr_b16 v[220:221], v239 offset:4096
    ds_read_b64_tr_b16 v[222:223], v239 offset:4608
    ds_read_b64_tr_b16 v[224:225], v241 offset:512
    ds_read_b64_tr_b16 v[226:227], v241 offset:576
    s_waitcnt lgkmcnt(12)
    v_mfma_f32_16x16x32_bf16 v[80:83], v[192:195], v[156:159], v[80:83]
    v_mfma_f32_16x16x32_bf16 v[84:87], v[196:199], v[156:159], v[84:87]
    v_mfma_f32_16x16x32_bf16 v[88:91], v[200:203], v[156:159], v[88:91]
    ds_read_b64_tr_b16 v[192:193], v237 offset:8192
    ds_read_b64_tr_b16 v[194:195], v237 offset:8704
    ds_read_b64_tr_b16 v[196:197], v239 offset:8192
    ds_read_b64_tr_b16 v[198:199], v239 offset:8704
    ds_read_b64_tr_b16 v[200:201], v241 offset:1024
    ds_read_b64_tr_b16 v[202:203], v241 offset:1088
    s_waitcnt lgkmcnt(12)
    v_mfma_f32_16x16x32_bf16 v[80:83], v[204:207], v[160:163], v[80:83]
    v_mfma_f32_16x16x32_bf16 v[84:87], v[208:211], v[160:163], v[84:87]
    v_mfma_f32_16x16x32_bf16 v[88:91], v[212:215], v[160:163], v[88:91]
    ds_read_b64_tr_b16 v[204:205], v237 offset:12288
    ds_read_b64_tr_b16 v[206:207], v237 offset:12800
    ds_read_b64_tr_b16 v[208:209], v239 offset:12288
    ds_read_b64_tr_b16 v[210:211], v239 offset:12800
    ds_read_b64_tr_b16 v[212:213], v241 offset:1536
    ds_read_b64_tr_b16 v[214:215], v241 offset:1600
    s_waitcnt lgkmcnt(12)
    v_mfma_f32_16x16x32_bf16 v[80:83], v[216:219], v[164:167], v[80:83]
    v_mfma_f32_16x16x32_bf16 v[84:87], v[220:223], v[164:167], v[84:87]
    v_mfma_f32_16x16x32_bf16 v[88:91], v[224:227], v[164:167], v[88:91]
    s_waitcnt lgkmcnt(6)
    v_mfma_f32_16x16x32_bf16 v[80:83], v[192:195], v[168:171], v[80:83]
    v_mfma_f32_16x16x32_bf16 v[84:87], v[196:199], v[168:171], v[84:87]
    v_mfma_f32_16x16x32_bf16 v[88:91], v[200:203], v[168:171], v[88:91]
    s_waitcnt lgkmcnt(0)
    v_mfma_f32_16x16x32_bf16 v[80:83], v[204:207], v[172:175], v[80:83]
    v_mfma_f32_16x16x32_bf16 v[84:87], v[208:211], v[172:175], v[84:87]
    v_mfma_f32_16x16x32_bf16 v[88:91], v[212:215], v[172:175], v[88:91]
    s_nop 5
    ds_bpermute_b32 v15, v186, v80
    v_cmp_eq_u32 vcc, 3, v3
    v_cvt_pk_bf16_f32 v176, v80, v81
    v_cvt_pk_bf16_f32 v177, v82, v83
    v_cvt_pk_bf16_f32 v178, v84, v85
    v_cvt_pk_bf16_f32 v179, v86, v87
    v_cvt_pk_bf16_f32 v181, v86, v85
    v_cvt_pk_bf16_f32 v182, v84, v83
    v_cvt_pk_bf16_f32 v183, v82, v81
    s_waitcnt lgkmcnt(0)
    v_cndmask_b32 v15, v15, v88, vcc
    v_cvt_pk_bf16_f32 v180, v15, v87
    s_cmp_lg_u32 s72, 0
    s_cbranch_scc1 pq_6
    v_lshlrev_b32 v4, 6, v1
    s_lshl_b32 s81, s75, 12
    s_add_u32 s81, s81, 9437184
pa_8:
    s_sleep 1
    buffer_load_dword v5, v4, s[64:67], s81 offen sc1
    s_waitcnt vmcnt(0)
    v_cmp_ne_u32 vcc, 1, v5
    s_nop 1
    s_cmp_lg_u64 vcc, 0
    s_cbranch_scc1 pa_8
pq_6:
    s_setprio 1
    s_barrier
    s_lshl_b32 s87, s93, 10
    s_add_u32 s87, s87, s95
    s_add_u32 s93, s93, 1
    s_and_b32 s93, s93, 15
    buffer_load_dwordx4 v[16:19], v232, s[64:67], s87 offen sc1
    buffer_load_dwordx4 v[20:23], v233, s[64:67], s87 offen sc1
    s_lshl_b32 s87, s93, 10
    s_add_u32 s87, s87, s95
    s_add_u32 s93, s93, 1
    s_and_b32 s93, s93, 15
    buffer_load_dwordx4 v[24:27], v232, s[64:67], s87 offen sc1
    buffer_load_dwordx4 v[28:31], v233, s[64:67], s87 offen sc1
    s_lshl_b32 s87, s93, 10
    s_add_u32 s87, s87, s95
    s_add_u32 s93, s93, 1
    s_and_b32 s93, s93, 15
    buffer_load_dwordx4 v[32:35], v232, s[64:67], s87 offen sc1
    buffer_load_dwordx4 v[36:39], v233, s[64:67], s87 offen sc1
    ds_read_b64_tr_b16 v[112:113], v228 offset:0
    ds_read_b64_tr_b16 v[114:115], v228 offset:2048
    ds_read_b64_tr_b16 v[116:117], v229 offset:0
    ds_read_b64_tr_b16 v[118:119], v229 offset:2048
    ds_read_b64_tr_b16 v[120:121], v230 offset:0
    ds_read_b64_tr_b16 v[122:123], v230 offset:2048
    ds_read_b64_tr_b16 v[124:125], v231 offset:0
    ds_read_b64_tr_b16 v[126:127], v231 offset:2048
    s_waitcnt vmcnt(4) lgkmcnt(0)
    v_mfma_f32_16x16x32_bf16 v[80:83], v[112:115], v[16:19], 0
    ds_read_b64_tr_b16 v[128:129], v228 offset:4096
    s_lshl_b32 s87, s93, 10
    s_add_u32 s87, s87, s95
    s_add_u32 s93, s93, 1
    s_and_b32 s93, s93, 15
    buffer_load_dwordx4 v[40:43], v232, s[64:67], s87 offen sc1
    v_mfma_f32_16x16x32_bf16 v[96:99], v[112:115], v[20:23], 0
    ds_read_b64_tr_b16 v[130:131], v228 offset:6144
    v_mfma_f32_16x16x32_bf16 v[84:87], v[116:119], v[16:19], 0
    ds_read_b64_tr_b16 v[132:133], v229 offset:4096
    v_mfma_f32_16x16x32_bf16 v[100:103], v[116:119], v[20:23], 0
    ds_read_b64_tr_b16 v[134:135], v229 offset:6144
    buffer_load_dwordx4 v[44:47], v233, s[64:67], s87 offen sc1
    v_mfma_f32_16x16x32_bf16 v[88:91], v[120:123], v[16:19], 0
    ds_read_b64_tr_b16 v[136:137], v230 offset:4096
    v_mfma_f32_16x16x32_bf16 v[104:107], v[120:123], v[20:23], 0
    ds_read_b64_tr_b16 v[138:139], v230 offset:6144
    v_mfma_f32_16x16x32_bf16 v[92:95], v[124:127], v[16:19], 0
    ds_read_b64_tr_b16 v[140:141], v231 offset:4096
    v_mfma_f32_16x16x32_bf16 v[108:111], v[124:127], v[20:23], 0
    ds_read_b64_tr_b16 v[142:143], v231 offset:6144
    s_waitcnt vmcnt(4) lgkmcnt(0)
    v_mfma_f32_16x16x32_bf16 v[80:83], v[128:131], v[24:27], v[80:83]
    ds_read_b64_tr_b16 v[112:113], v228 offset:8192
    s_lshl_b32 s87, s93, 10
    s_add_u32 s87, s87, s95
    s_add_u32 s93, s93, 1
    s_and_b32 s93, s93, 15
    buffer_load_dwordx4 v[48:51], v232, s[64:67], s87 offen sc1
    v_mfma_f32_16x16x32_bf16 v[96:99], v[128:131], v[28:31], v[96:99]
    ds_read_b64_tr_b16 v[114:115], v228 offset:10240
    v_mfma_f32_16x16x32_bf16 v[84:87], v[132:135], v[24:27], v[84:87]
    ds_read_b64_tr_b16 v[116:117], v229 offset:8192
    v_mfma_f32_16x16x32_bf16 v[100:103], v[132:135], v[28:31], v[100:103]
    ds_read_b64_tr_b16 v[118:119], v229 offset:10240
    buffer_load_dwordx4 v[52:55], v233, s[64:67], s87 offen sc1
    v_mfma_f32_16x16x32_bf16 v[88:91], v[136:139], v[24:27], v[88:91]
    ds_read_b64_tr_b16 v[120:121], v230 offset:8192
    v_mfma_f32_16x16x32_bf16 v[104:107], v[136:139], v[28:31], v[104:107]
    ds_read_b64_tr_b16 v[122:123], v230 offset:10240
    v_mfma_f32_16x16x32_bf16 v[92:95], v[140:143], v[24:27], v[92:95]
    ds_read_b64_tr_b16 v[124:125], v231 offset:8192
    v_mfma_f32_16x16x32_bf16 v[108:111], v[140:143], v[28:31], v[108:111]
    ds_read_b64_tr_b16 v[126:127], v231 offset:10240
    s_waitcnt vmcnt(4) lgkmcnt(0)
    v_mfma_f32_16x16x32_bf16 v[80:83], v[112:115], v[32:35], v[80:83]
    ds_read_b64_tr_b16 v[128:129], v228 offset:12288
    s_lshl_b32 s87, s93, 10
    s_add_u32 s87, s87, s95
    s_add_u32 s93, s93, 1
    s_and_b32 s93, s93, 15
    buffer_load_dwordx4 v[56:59], v232, s[64:67], s87 offen sc1
    v_mfma_f32_16x16x32_bf16 v[96:99], v[112:115], v[36:39], v[96:99]
    ds_read_b64_tr_b16 v[130:131], v228 offset:14336
    v_mfma_f32_16x16x32_bf16 v[84:87], v[116:119], v[32:35], v[84:87]
    ds_read_b64_tr_b16 v[132:133], v229 offset:12288
    v_mfma_f32_16x16x32_bf16 v[100:103], v[116:119], v[36:39], v[100:103]
    ds_read_b64_tr_b16 v[134:135], v229 offset:14336
    buffer_load_dwordx4 v[60:63], v233, s[64:67], s87 offen sc1
    v_mfma_f32_16x16x32_bf16 v[88:91], v[120:123], v[32:35], v[88:91]
    ds_read_b64_tr_b16 v[136:137], v230 offset:12288
    v_mfma_f32_16x16x32_bf16 v[104:107], v[120:123], v[36:39], v[104:107]
    ds_read_b64_tr_b16 v[138:139], v230 offset:14336
    v_mfma_f32_16x16x32_bf16 v[92:95], v[124:127], v[32:35], v[92:95]
    ds_read_b64_tr_b16 v[140:141], v231 offset:12288
    v_mfma_f32_16x16x32_bf16 v[108:111], v[124:127], v[36:39], v[108:111]
    ds_read_b64_tr_b16 v[142:143], v231 offset:14336
    s_waitcnt vmcnt(4) lgkmcnt(0)
    v_mfma_f32_16x16x32_bf16 v[80:83], v[128:131], v[40:43], v[80:83]
    ds_read_b64_tr_b16 v[112:113], v228 offset:16384
    s_lshl_b32 s87, s93, 10
    s_add_u32 s87, s87, s95
    s_add_u32 s93, s93, 1
    s_and_b32 s93, s93, 15
    buffer_load_dwordx4 v[64:67], v232, s[64:67], s87 offen sc1
    v_mfma_f32_16x16x32_bf16 v[96:99], v[128:131], v[44:47], v[96:99]
    ds_read_b64_tr_b16 v[114:115], v228 offset:18432
    v_mfma_f32_16x16x32_bf16 v[84:87], v[132:135], v[40:43], v[84:87]
    ds_read_b64_tr_b16 v[116:117], v229 offset:16384
    v_mfma_f32_16x16x32_bf16 v[100:103], v[132:135], v[44:47], v[100:103]
    ds_read_b64_tr_b16 v[118:119], v229 offset:18432
    buffer_load_dwordx4 v[68:71], v233, s[64:67], s87 offen sc1
    v_mfma_f32_16x16x32_bf16 v[88:91], v[136:139], v[40:43], v[88:91]
    ds_read_b64_tr_b16 v[120:121], v230 offset:16384
    v_mfma_f32_16x16x32_bf16 v[104:107], v[136:139], v[44:47], v[104:107]
    ds_read_b64_tr_b16 v[122:123], v230 offset:18432
    v_mfma_f32_16x16x32_bf16 v[92:95], v[140:143], v[40:43], v[92:95]
    ds_read_b64_tr_b16 v[124:125], v231 offset:16384
    v_mfma_f32_16x16x32_bf16 v[108:111], v[140:143], v[44:47], v[108:111]
    ds_read_b64_tr_b16 v[126:127], v231 offset:18432
    s_waitcnt vmcnt(4) lgkmcnt(0)
    v_mfma_f32_16x16x32_bf16 v[80:83], v[112:115], v[48:51], v[80:83]
    ds_read_b64_tr_b16 v[128:129], v228 offset:20480
    s_lshl_b32 s87, s93, 10
    s_add_u32 s87, s87, s95
    s_add_u32 s93, s93, 1
    s_and_b32 s93, s93, 15
    buffer_load_dwordx4 v[72:75], v232, s[64:67], s87 offen sc1
    v_mfma_f32_16x16x32_bf16 v[96:99], v[112:115], v[52:55], v[96:99]
    ds_read_b64_tr_b16 v[130:131], v228 offset:22528
    v_mfma_f32_16x16x32_bf16 v[84:87], v[116:119], v[48:51], v[84:87]
    ds_read_b64_tr_b16 v[132:133], v229 offset:20480
    v_mfma_f32_16x16x32_bf16 v[100:103], v[116:119], v[52:55], v[100:103]
    ds_read_b64_tr_b16 v[134:135], v229 offset:22528
    buffer_load_dwordx4 v[76:79], v233, s[64:67], s87 offen sc1
    v_mfma_f32_16x16x32_bf16 v[88:91], v[120:123], v[48:51], v[88:91]
    ds_read_b64_tr_b16 v[136:137], v230 offset:20480
    v_mfma_f32_16x16x32_bf16 v[104:107], v[120:123], v[52:55], v[104:107]
    ds_read_b64_tr_b16 v[138:139], v230 offset:22528
    v_mfma_f32_16x16x32_bf16 v[92:95], v[124:127], v[48:51], v[92:95]
    ds_read_b64_tr_b16 v[140:141], v231 offset:20480
    v_mfma_f32_16x16x32_bf16 v[108:111], v[124:127], v[52:55], v[108:111]
    ds_read_b64_tr_b16 v[142:143], v231 offset:22528
    s_waitcnt vmcnt(4) lgkmcnt(0)
    v_mfma_f32_16x16x32_bf16 v[80:83], v[128:131], v[56:59], v[80:83]
    ds_read_b64_tr_b16 v[112:113], v228 offset:24576
    s_lshl_b32 s87, s93, 10
    s_add_u32 s87, s87, s95
    s_add_u32 s93, s93, 1
    s_and_b32 s93, s93, 15
    buffer_load_dwordx4 v[16:19], v232, s[64:67], s87 offen sc1
    v_mfma_f32_16x16x32_bf16 v[96:99], v[128:131], v[60:63], v[96:99]
    ds_read_b64_tr_b16 v[114:115], v228 offset:26624
    v_mfma_f32_16x16x32_bf16 v[84:87], v[132:135], v[56:59], v[84:87]
    ds_read_b64_tr_b16 v[116:117], v229 offset:24576
    v_mfma_f32_16x16x32_bf16 v[100:103], v[132:135], v[60:63], v[100:103]
    ds_read_b64_tr_b16 v[118:119], v229 offset:26624
    buffer_load_dwordx4 v[20:23], v233, s[64:67], s87 offen sc1
    v_mfma_f32_16x16x32_bf16 v[88:91], v[136:139], v[56:59], v[88:91]
    ds_read_b64_tr_b16 v[120:121], v230 offset:24576
    v_mfma_f32_16x16x32_bf16 v[104:107], v[136:139], v[60:63], v[104:107]
    ds_read_b64_tr_b16 v[122:123], v230 offset:26624
    v_mfma_f32_16x16x32_bf16 v[92:95], v[140:143], v[56:59], v[92:95]
    ds_read_b64_tr_b16 v[124:125], v231 offset:24576
    v_mfma_f32_16x16x32_bf16 v[108:111], v[140:143], v[60:63], v[108:111]
    ds_read_b64_tr_b16 v[126:127], v231 offset:26624
    s_waitcnt vmcnt(4) lgkmcnt(0)
    s_barrier
    v_mfma_f32_16x16x32_bf16 v[80:83], v[112:115], v[64:67], v[80:83]
    ds_read_b64_tr_b16 v[128:129], v228 offset:28672
    s_lshl_b32 s87, s93, 10
    s_add_u32 s87, s87, s95
    s_add_u32 s93, s93, 1
    s_and_b32 s93, s93, 15
    buffer_load_dwordx4 v[24:27], v232, s[64:67], s87 offen sc1
    v_mfma_f32_16x16x32_bf16 v[96:99], v[112:115], v[68:71], v[96:99]
    ds_read_b64_tr_b16 v[130:131], v228 offset:30720
    v_mfma_f32_16x16x32_bf16 v[84:87], v[116:119], v[64:67], v[84:87]
    ds_read_b64_tr_b16 v[132:133], v229 offset:28672
    v_mfma_f32_16x16x32_bf16 v[100:103], v[116:119], v[68:71], v[100:103]
    ds_read_b64_tr_b16 v[134:135], v229 offset:30720
    buffer_load_dwordx4 v[28:31], v233, s[64:67], s87 offen sc1
    v_mfma_f32_16x16x32_bf16 v[88:91], v[120:123], v[64:67], v[88:91]
    ds_read_b64_tr_b16 v[136:137], v230 offset:28672
    v_mfma_f32_16x16x32_bf16 v[104:107], v[120:123], v[68:71], v[104:107]
    ds_read_b64_tr_b16 v[138:139], v230 offset:30720
    v_mfma_f32_16x16x32_bf16 v[92:95], v[124:127], v[64:67], v[92:95]
    ds_read_b64_tr_b16 v[140:141], v231 offset:28672
    v_mfma_f32_16x16x32_bf16 v[108:111], v[124:127], v[68:71], v[108:111]
    ds_read_b64_tr_b16 v[142:143], v231 offset:30720
    s_waitcnt vmcnt(4) lgkmcnt(0)
    v_mfma_f32_16x16x32_bf16 v[80:83], v[128:131], v[72:75], v[80:83]
    ds_read_b64_tr_b16 v[112:113], v228 offset:32768
    s_lshl_b32 s87, s93, 10
    s_add_u32 s87, s87, s95
    s_add_u32 s93, s93, 1
    s_and_b32 s93, s93, 15
    buffer_load_dwordx4 v[32:35], v232, s[64:67], s87 offen sc1
    v_mfma_f32_16x16x32_bf16 v[96:99], v[128:131], v[76:79], v[96:99]
    ds_read_b64_tr_b16 v[114:115], v228 offset:34816
    v_mfma_f32_16x16x32_bf16 v[84:87], v[132:135], v[72:75], v[84:87]
    ds_read_b64_tr_b16 v[116:117], v229 offset:32768
    v_mfma_f32_16x16x32_bf16 v[100:103], v[132:135], v[76:79], v[100:103]
    ds_read_b64_tr_b16 v[118:119], v229 offset:34816
    buffer_load_dwordx4 v[36:39], v233, s[64:67], s87 offen sc1
    v_mfma_f32_16x16x32_bf16 v[88:91], v[136:139], v[72:75], v[88:91]
    ds_read_b64_tr_b16 v[120:121], v230 offset:32768
    v_mfma_f32_16x16x32_bf16 v[104:107], v[136:139], v[76:79], v[104:107]
    ds_read_b64_tr_b16 v[122:123], v230 offset:34816
    v_mfma_f32_16x16x32_bf16 v[92:95], v[140:143], v[72:75], v[92:95]
    ds_read_b64_tr_b16 v[124:125], v231 offset:32768
    v_mfma_f32_16x16x32_bf16 v[108:111], v[140:143], v[76:79], v[108:111]
    ds_read_b64_tr_b16 v[126:127], v231 offset:34816
    s_waitcnt vmcnt(4) lgkmcnt(0)
    v_mfma_f32_16x16x32_bf16 v[80:83], v[112:115], v[16:19], v[80:83]
    ds_read_b64_tr_b16 v[128:129], v228 offset:36864
    s_lshl_b32 s87, s93, 10
    s_add_u32 s87, s87, s95
    s_add_u32 s93, s93, 1
    s_and_b32 s93, s93, 15
    buffer_load_dwordx4 v[40:43], v232, s[64:67], s87 offen sc1
    v_mfma_f32_16x16x32_bf16 v[96:99], v[112:115], v[20:23], v[96:99]
    ds_read_b64_tr_b16 v[130:131], v228 offset:38912
    v_mfma_f32_16x16x32_bf16 v[84:87], v[116:119], v[16:19], v[84:87]
    ds_read_b64_tr_b16 v[132:133], v229 offset:36864
    v_mfma_f32_16x16x32_bf16 v[100:103], v[116:119], v[20:23], v[100:103]
    ds_read_b64_tr_b16 v[134:135], v229 offset:38912
    buffer_load_dwordx4 v[44:47], v233, s[64:67], s87 offen sc1
    v_mfma_f32_16x16x32_bf16 v[88:91], v[120:123], v[16:19], v[88:91]
    ds_read_b64_tr_b16 v[136:137], v230 offset:36864
    v_mfma_f32_16x16x32_bf16 v[104:107], v[120:123], v[20:23], v[104:107]
    ds_read_b64_tr_b16 v[138:139], v230 offset:38912
    v_mfma_f32_16x16x32_bf16 v[92:95], v[124:127], v[16:19], v[92:95]
    ds_read_b64_tr_b16 v[140:141], v231 offset:36864
    v_mfma_f32_16x16x32_bf16 v[108:111], v[124:127], v[20:23], v[108:111]
    ds_read_b64_tr_b16 v[142:143], v231 offset:38912
    s_waitcnt vmcnt(4) lgkmcnt(0)
    v_mfma_f32_16x16x32_bf16 v[80:83], v[128:131], v[24:27], v[80:83]
    ds_read_b64_tr_b16 v[112:113], v228 offset:40960
    s_lshl_b32 s87, s93, 10
    s_add_u32 s87, s87, s95
    s_add_u32 s93, s93, 1
    s_and_b32 s93, s93, 15
    buffer_load_dwordx4 v[48:51], v232, s[64:67], s87 offen sc1
    v_mfma_f32_16x16x32_bf16 v[96:99], v[128:131], v[28:31], v[96:99]
    ds_read_b64_tr_b16 v[114:115], v228 offset:43008
    v_mfma_f32_16x16x32_bf16 v[84:87], v[132:135], v[24:27], v[84:87]
    ds_read_b64_tr_b16 v[116:117], v229 offset:40960
    v_mfma_f32_16x16x32_bf16 v[100:103], v[132:135], v[28:31], v[100:103]
    ds_read_b64_tr_b16 v[118:119], v229 offset:43008
    buffer_load_dwordx4 v[52:55], v233, s[64:67], s87 offen sc1
    v_mfma_f32_16x16x32_bf16 v[88:91], v[136:139], v[24:27], v[88:91]
    ds_read_b64_tr_b16 v[120:121], v230 offset:40960
    v_mfma_f32_16x16x32_bf16 v[104:107], v[136:139], v[28:31], v[104:107]
    ds_read_b64_tr_b16 v[122:123], v230 offset:43008
    v_mfma_f32_16x16x32_bf16 v[92:95], v[140:143], v[24:27], v[92:95]
    ds_read_b64_tr_b16 v[124:125], v231 offset:40960
    v_mfma_f32_16x16x32_bf16 v[108:111], v[140:143], v[28:31], v[108:111]
    ds_read_b64_tr_b16 v[126:127], v231 offset:43008
    s_waitcnt vmcnt(4) lgkmcnt(0)
    v_mfma_f32_16x16x32_bf16 v[80:83], v[112:115], v[32:35], v[80:83]
    ds_read_b64_tr_b16 v[128:129], v228 offset:45056
    s_lshl_b32 s87, s93, 10
    s_add_u32 s87, s87, s95
    s_add_u32 s93, s93, 1
    s_and_b32 s93, s93, 15
    buffer_load_dwordx4 v[56:59], v232, s[64:67], s87 offen sc1
    v_mfma_f32_16x16x32_bf16 v[96:99], v[112:115], v[36:39], v[96:99]
    ds_read_b64_tr_b16 v[130:131], v228 offset:47104
    v_mfma_f32_16x16x32_bf16 v[84:87], v[116:119], v[32:35], v[84:87]
    ds_read_b64_tr_b16 v[132:133], v229 offset:45056
    v_mfma_f32_16x16x32_bf16 v[100:103], v[116:119], v[36:39], v[100:103]
    ds_read_b64_tr_b16 v[134:135], v229 offset:47104
    buffer_load_dwordx4 v[60:63], v233, s[64:67], s87 offen sc1
    v_mfma_f32_16x16x32_bf16 v[88:91], v[120:123], v[32:35], v[88:91]
    ds_read_b64_tr_b16 v[136:137], v230 offset:45056
    v_mfma_f32_16x16x32_bf16 v[104:107], v[120:123], v[36:39], v[104:107]
    ds_read_b64_tr_b16 v[138:139], v230 offset:47104
    v_mfma_f32_16x16x32_bf16 v[92:95], v[124:127], v[32:35], v[92:95]
    ds_read_b64_tr_b16 v[140:141], v231 offset:45056
    v_mfma_f32_16x16x32_bf16 v[108:111], v[124:127], v[36:39], v[108:111]
    ds_read_b64_tr_b16 v[142:143], v231 offset:47104
    s_waitcnt vmcnt(4) lgkmcnt(0)
    v_mfma_f32_16x16x32_bf16 v[80:83], v[128:131], v[40:43], v[80:83]
    ds_read_b64_tr_b16 v[112:113], v228 offset:49152
    s_lshl_b32 s87, s93, 10
    s_add_u32 s87, s87, s95
    s_add_u32 s93, s93, 1
    s_and_b32 s93, s93, 15
    buffer_load_dwordx4 v[64:67], v232, s[64:67], s87 offen sc1
    v_mfma_f32_16x16x32_bf16 v[96:99], v[128:131], v[44:47], v[96:99]
    ds_read_b64_tr_b16 v[114:115], v228 offset:51200
    v_mfma_f32_16x16x32_bf16 v[84:87], v[132:135], v[40:43], v[84:87]
    ds_read_b64_tr_b16 v[116:117], v229 offset:49152
    v_mfma_f32_16x16x32_bf16 v[100:103], v[132:135], v[44:47], v[100:103]
    ds_read_b64_tr_b16 v[118:119], v229 offset:51200
    buffer_load_dwordx4 v[68:71], v233, s[64:67], s87 offen sc1
    v_mfma_f32_16x16x32_bf16 v[88:91], v[136:139], v[40:43], v[88:91]
    ds_read_b64_tr_b16 v[120:121], v230 offset:49152
    v_mfma_f32_16x16x32_bf16 v[104:107], v[136:139], v[44:47], v[104:107]
    ds_read_b64_tr_b16 v[122:123], v230 offset:51200
    v_mfma_f32_16x16x32_bf16 v[92:95], v[140:143], v[40:43], v[92:95]
    ds_read_b64_tr_b16 v[124:125], v231 offset:49152
    v_mfma_f32_16x16x32_bf16 v[108:111], v[140:143], v[44:47], v[108:111]
    ds_read_b64_tr_b16 v[126:127], v231 offset:51200
    s_waitcnt vmcnt(4) lgkmcnt(0)
    v_mfma_f32_16x16x32_bf16 v[80:83], v[112:115], v[48:51], v[80:83]
    ds_read_b64_tr_b16 v[128:129], v228 offset:53248
    s_lshl_b32 s87, s93, 10
    s_add_u32 s87, s87, s95
    s_add_u32 s93, s93, 1
    s_and_b32 s93, s93, 15
    buffer_load_dwordx4 v[72:75], v232, s[64:67], s87 offen sc1
    v_mfma_f32_16x16x32_bf16 v[96:99], v[112:115], v[52:55], v[96:99]
    ds_read_b64_tr_b16 v[130:131], v228 offset:55296
    v_mfma_f32_16x16x32_bf16 v[84:87], v[116:119], v[48:51], v[84:87]
    ds_read_b64_tr_b16 v[132:133], v229 offset:53248
    v_mfma_f32_16x16x32_bf16 v[100:103], v[116:119], v[52:55], v[100:103]
    ds_read_b64_tr_b16 v[134:135], v229 offset:55296
    buffer_load_dwordx4 v[76:79], v233, s[64:67], s87 offen sc1
    v_mfma_f32_16x16x32_bf16 v[88:91], v[120:123], v[48:51], v[88:91]
    ds_read_b64_tr_b16 v[136:137], v230 offset:53248
    v_mfma_f32_16x16x32_bf16 v[104:107], v[120:123], v[52:55], v[104:107]
    ds_read_b64_tr_b16 v[138:139], v230 offset:55296
    v_mfma_f32_16x16x32_bf16 v[92:95], v[124:127], v[48:51], v[92:95]
    ds_read_b64_tr_b16 v[140:141], v231 offset:53248
    v_mfma_f32_16x16x32_bf16 v[108:111], v[124:127], v[52:55], v[108:111]
    ds_read_b64_tr_b16 v[142:143], v231 offset:55296
    buffer_store_dwordx4 v[176:179], v185, s[60:63], 0 offen nt
    s_waitcnt vmcnt(5) lgkmcnt(0)
    v_mfma_f32_16x16x32_bf16 v[80:83], v[128:131], v[56:59], v[80:83]
    ds_read_b64_tr_b16 v[112:113], v228 offset:57344
    v_mfma_f32_16x16x32_bf16 v[96:99], v[128:131], v[60:63], v[96:99]
    ds_read_b64_tr_b16 v[114:115], v228 offset:59392
    v_mfma_f32_16x16x32_bf16 v[84:87], v[132:135], v[56:59], v[84:87]
    ds_read_b64_tr_b16 v[116:117], v229 offset:57344
    v_mfma_f32_16x16x32_bf16 v[100:103], v[132:135], v[60:63], v[100:103]
    ds_read_b64_tr_b16 v[118:119], v229 offset:59392
    v_mfma_f32_16x16x32_bf16 v[88:91], v[136:139], v[56:59], v[88:91]
    ds_read_b64_tr_b16 v[120:121], v230 offset:57344
    v_mfma_f32_16x16x32_bf16 v[104:107], v[136:139], v[60:63], v[104:107]
    ds_read_b64_tr_b16 v[122:123], v230 offset:59392
    v_mfma_f32_16x16x32_bf16 v[92:95], v[140:143], v[56:59], v[92:95]
    ds_read_b64_tr_b16 v[124:125], v231 offset:57344
    v_mfma_f32_16x16x32_bf16 v[108:111], v[140:143], v[60:63], v[108:111]
    ds_read_b64_tr_b16 v[126:127], v231 offset:59392
    s_waitcnt vmcnt(3) lgkmcnt(0)
    v_mfma_f32_16x16x32_bf16 v[80:83], v[112:115], v[64:67], v[80:83]
    ds_read_b64_tr_b16 v[128:129], v228 offset:61440
    v_mfma_f32_16x16x32_bf16 v[96:99], v[112:115], v[68:71], v[96:99]
    ds_read_b64_tr_b16 v[130:131], v228 offset:63488
    v_mfma_f32_16x16x32_bf16 v[84:87], v[116:119], v[64:67], v[84:87]
    ds_read_b64_tr_b16 v[132:133], v229 offset:61440
    v_mfma_f32_16x16x32_bf16 v[100:103], v[116:119], v[68:71], v[100:103]
    ds_read_b64_tr_b16 v[134:135], v229 offset:63488
    v_mfma_f32_16x16x32_bf16 v[88:91], v[120:123], v[64:67], v[88:91]
    ds_read_b64_tr_b16 v[136:137], v230 offset:61440
    v_mfma_f32_16x16x32_bf16 v[104:107], v[120:123], v[68:71], v[104:107]
    ds_read_b64_tr_b16 v[138:139], v230 offset:63488
    v_mfma_f32_16x16x32_bf16 v[92:95], v[124:127], v[64:67], v[92:95]
    ds_read_b64_tr_b16 v[140:141], v231 offset:61440
    v_mfma_f32_16x16x32_bf16 v[108:111], v[124:127], v[68:71], v[108:111]
    ds_read_b64_tr_b16 v[142:143], v231 offset:63488
    buffer_store_dwordx4 v[180:183], v184, s[60:63], 0 offen nt
    s_waitcnt vmcnt(2) lgkmcnt(0)
    v_mfma_f32_16x16x32_bf16 v[80:83], v[128:131], v[72:75], v[80:83]
    v_mfma_f32_16x16x32_bf16 v[96:99], v[128:131], v[76:79], v[96:99]
    v_mfma_f32_16x16x32_bf16 v[84:87], v[132:135], v[72:75], v[84:87]
    v_mfma_f32_16x16x32_bf16 v[100:103], v[132:135], v[76:79], v[100:103]
    v_mfma_f32_16x16x32_bf16 v[88:91], v[136:139], v[72:75], v[88:91]
    v_mfma_f32_16x16x32_bf16 v[104:107], v[136:139], v[76:79], v[104:107]
    v_mfma_f32_16x16x32_bf16 v[92:95], v[140:143], v[72:75], v[92:95]
    v_mfma_f32_16x16x32_bf16 v[108:111], v[140:143], v[76:79], v[108:111]
    s_lshl_b32 s84, s72, 12
    v_add_u32 v6, s84, v232
    v_add_u32 v7, 0x10000, v6
    s_lshl_b32 s84, s72, 2
    s_add_u32 s84, s84, 155680
    v_mov_b32 v8, s84
    ds_write_b128 v6, v[80:83] offset:0
    ds_write_b128 v6, v[84:87] offset:1024
    ds_write_b128 v6, v[88:91] offset:2048
    ds_write_b128 v6, v[92:95] offset:3072
    ds_write_b128 v7, v[96:99] offset:0
    ds_write_b128 v7, v[100:103] offset:1024
    ds_write_b128 v7, v[104:107] offset:2048
    ds_write_b128 v7, v[108:111] offset:3072
    v_mov_b32 v5, 1
    s_mov_b64 exec, 1
    ds_add_u32 v8, v5
    s_mov_b64 exec, -1
    s_branch L_out
L_pf:
    s_and_b32 s81, s2, 1
    s_bfe_u32 s82, s2, 0x20001
    s_lshr_b32 s83, s2, 3
    s_lshl_b32 s12, s81, 10
    s_lshl_b32 s85, s82, 8
    s_add_u32 s12, s12, s85
    s_lshl_b32 s85, s83, 3
    s_add_u32 s12, s12, s85
    s_lshl_b32 s12, s12, 11
    s_lshl_b32 s13, s81, 5
    s_add_u32 s13, s13, s83
    s_mul_i32 s13, s13, 6144
    s_lshl_b32 s85, s82, 9
    s_add_u32 s13, s13, s85
    s_lshl_b32 s15, s2, 13
    s_xor_b32 s81, s81, 1
    s_lshl_b32 s19, s81, 5
    s_add_u32 s19, s19, s83
    s_mul_i32 s19, s19, 6144
    s_add_u32 s19, s19, s85
    s_add_u32 s19, s19, 384
    s_barrier
    s_and_b32 s81, s72, 3
    s_lshl_b32 s82, s81, 7
    s_add_u32 s82, s82, s13
    s_lshl_b32 s83, s81, 12
    s_add_u32 s83, s83, s12
    s_min_u32 s81, s81, 2
    s_lshl_b32 s81, s81, 11
    s_add_u32 s81, s81, s19
    s_buffer_load_dwordx2 s[44:45], s[32:35], s82 offset:60
    s_buffer_load_dwordx2 s[44:45], s[32:35], s82 offset:2108
    s_buffer_load_dwordx2 s[44:45], s[32:35], s82 offset:4156
    s_buffer_load_dwordx2 s[44:45], s[28:31], s83 offset:60
    s_buffer_load_dwordx2 s[44:45], s[28:31], s83 offset:2108
    s_buffer_load_dwordx2 s[44:45], s[32:35], s81 offset:60
    v_mov_b32 v188, 0
    v_mov_b32 v189, 0
    v_mov_b32 v190, 0
    v_mov_b32 v191, 0
    v_mov_b32 v186, 1
    v_lshlrev_b32 v183, 7, v1
    s_mov_b64 s[48:49], s[12:13]
    s_mov_b32 s50, s19
    s_cmp_lg_u32 s72, 7
    s_cbranch_scc1 only_9
    s_waitcnt lgkmcnt(0)
only_9:
    s_cmp_lg_u32 s72, 7
    s_cbranch_scc1 only_10
    v_lshrrev_b32 v5, 2, v1
    v_add_u32 v5, 1, v5
    s_mov_b32 s81, 393216
    v_mul_lo_u32 v6, v5, s81
    v_cmp_gt_u32 vcc, 9, v5
    v_bfrev_b32 v7, 1
    v_and_b32 v4, 3, v1
    v_cndmask_b32 v6, v7, v6, vcc
    v_lshl_add_u32 v8, v4, 7, v6
    s_add_u32 s81, s49, 0
    buffer_load_dword v184, v8, s[32:35], s81 offen
    s_add_u32 s81, s49, 2048
    buffer_load_dword v184, v8, s[32:35], s81 offen
    s_add_u32 s81, s49, 4096
    buffer_load_dword v184, v8, s[32:35], s81 offen
    v_cmp_gt_u32 vcc, 3, v4
    v_lshl_add_u32 v8, v4, 11, v6
    v_and_b32 v4, 7, v1
    v_cndmask_b32 v8, v7, v8, vcc
    buffer_load_dword v184, v8, s[32:35], s50 offen
    v_lshrrev_b32 v5, 3, v1
    v_add_u32 v5, 1, v5
    v_cmp_gt_u32 vcc, 9, v5
    v_lshlrev_b32 v5, 7, v5
    v_lshl_add_u32 v5, v4, 11, v5
    v_cndmask_b32 v5, v7, v5, vcc
    buffer_load_dword v184, v5, s[28:31], s48 offen
only_10:
    s_cmp_lg_u32 s72, 6
    s_cbranch_scc1 only_11
    s_cmp_ge_u32 s2, 16
    s_cbranch_scc1 clr_12
    v_lshlrev_b32 v4, 4, v1
    s_lshl_b32 s81, s2, 12
    s_add_u32 s81, s81, 9437184
    s_lshl_b32 s82, s2, 6
    s_add_u32 s82, s82, 9502720
    buffer_store_dwordx4 v[188:191], v4, s[64:67], s81 offen offset:0 sc1
    buffer_store_dwordx4 v[188:191], v4, s[64:67], s81 offen offset:1024 sc1
    buffer_store_dwordx4 v[188:191], v4, s[64:67], s81 offen offset:2048 sc1
    buffer_store_dwordx4 v[188:191], v4, s[64:67], s81 offen offset:3072 sc1
    s_mov_b64 exec, 15
    buffer_store_dwordx4 v[188:191], v4, s[64:67], s82 offen sc1
    s_mov_b64 exec, -1
clr_12:
only_11:
    s_and_b32 s81, s72, 1
    s_lshl_b32 s82, s81, 7
    s_add_u32 s13, s13, s82
    s_add_u32 s15, s15, s82
    s_lshl_b32 s82, s81, 11
    s_add_u32 s12, s12, s82
    s_add_u32 s19, s19, s82
    v_lshlrev_b32 v5, 1, v3
    v_and_b32 v6, 7, v1
    v_xor_b32 v5, v5, v6
    v_lshlrev_b32 v5, 4, v5
    v_lshrrev_b32 v6, 3, v1
    v_lshl_add_u32 v5, v6, 11, v5
    s_lshl_b32 s81, s76, 7
    v_add_u32 v244, s81, v5
    v_lshlrev_b32 v232, 4, v1
    s_cmp_lg_u32 s72, 6
    s_cbranch_scc1 only_13
    s_cmp_ge_u32 s2, 16
    s_cbranch_scc1 ann_14
    s_lshl_b32 s81, s2, 2
    s_waitcnt vmcnt(0)
    s_mov_b64 exec, 1
    buffer_store_dword v186, v188, s[68:71], s81 offen sc1
    s_mov_b64 exec, -1
ann_14:
only_13:
    v_lshlrev_b32 v187, 2, v2
    s_barrier
    s_barrier
    s_and_b32 s81, s72, 1
    s_lshl_b32 s81, s81, 14
    s_add_u32 s81, s81, 132096
    v_add_u32 v4, s81, v232
    v_add_u32 v5, 130048, v232
    ds_read_b128 v[32:35], v4 offset:0
    ds_read_b128 v[36:39], v4 offset:2048
    ds_read_b128 v[40:43], v4 offset:4096
    ds_read_b128 v[44:47], v4 offset:6144
    ds_read_b128 v[48:51], v4 offset:8192
    ds_read_b128 v[52:55], v4 offset:10240
    ds_read_b128 v[56:59], v4 offset:12288
    ds_read_b128 v[60:63], v4 offset:14336
    ds_read_b128 v[64:67], v5
    s_waitcnt lgkmcnt(0)
    s_add_u32 s14, s13, 3538944
    s_buffer_load_dwordx2 s[44:45], s[32:35], s14 offset:60
    s_buffer_load_dwordx2 s[44:45], s[32:35], s14 offset:316
    s_buffer_load_dwordx2 s[44:45], s[32:35], s14 offset:2108
    s_buffer_load_dwordx2 s[44:45], s[32:35], s14 offset:2364
    s_buffer_load_dwordx2 s[44:45], s[32:35], s14 offset:4156
    s_buffer_load_dwordx2 s[44:45], s[32:35], s14 offset:4412
    s_buffer_load_dwordx2 s[44:45], s[28:31], s12 offset:1212
    s_buffer_load_dwordx2 s[44:45], s[28:31], s12 offset:5308
    s_buffer_load_dwordx2 s[44:45], s[28:31], s12 offset:9404
    s_buffer_load_dwordx2 s[44:45], s[28:31], s12 offset:13500
    s_add_u32 s14, s19, 3538944
    s_buffer_load_dwordx2 s[44:45], s[32:35], s14 offset:60
    s_buffer_load_dwordx2 s[44:45], s[32:35], s14 offset:2108
    s_barrier
    s_add_u32 s14, s13, 3932160
    s_buffer_load_dwordx2 s[44:45], s[32:35], s14 offset:60
    s_buffer_load_dwordx2 s[44:45], s[32:35], s14 offset:316
    s_buffer_load_dwordx2 s[44:45], s[32:35], s14 offset:2108
    s_buffer_load_dwordx2 s[44:45], s[32:35], s14 offset:2364
    s_buffer_load_dwordx2 s[44:45], s[32:35], s14 offset:4156
    s_buffer_load_dwordx2 s[44:45], s[32:35], s14 offset:4412
    s_buffer_load_dwordx2 s[44:45], s[28:31], s12 offset:1340
    s_barrier
    s_buffer_load_dwordx2 s[44:45], s[28:31], s12 offset:5436
    s_buffer_load_dwordx2 s[44:45], s[28:31], s12 offset:9532
    s_buffer_load_dwordx2 s[44:45], s[28:31], s12 offset:13628
    s_add_u32 s14, s19, 3932160
    s_buffer_load_dwordx2 s[44:45], s[32:35], s14 offset:60
    s_buffer_load_dwordx2 s[44:45], s[32:35], s14 offset:2108
    s_add_u32 s14, s13, 4325376
    s_buffer_load_dwordx2 s[44:45], s[32:35], s14 offset:60
    s_buffer_load_dwordx2 s[44:45], s[32:35], s14 offset:316
    s_barrier
    s_buffer_load_dwordx2 s[44:45], s[32:35], s14 offset:2108
    s_buffer_load_dwordx2 s[44:45], s[32:35], s14 offset:2364
    s_buffer_load_dwordx2 s[44:45], s[32:35], s14 offset:4156
    s_buffer_load_dwordx2 s[44:45], s[32:35], s14 offset:4412
    s_buffer_load_dwordx2 s[44:45], s[28:31], s12 offset:1468
    s_buffer_load_dwordx2 s[44:45], s[28:31], s12 offset:5564
    s_buffer_load_dwordx2 s[44:45], s[28:31], s12 offset:9660
    s_barrier
    s_cmp_lg_u32 s72, 7
    s_cbranch_scc1 only_15
only_15:
    s_buffer_load_dwordx2 s[44:45], s[28:31], s12 offset:13756
    s_add_u32 s14, s19, 4325376
    s_buffer_load_dwordx2 s[44:45], s[32:35], s14 offset:60
    s_buffer_load_dwordx2 s[44:45], s[32:35], s14 offset:2108
    s_add_u32 s14, s13, 4718592
    s_buffer_load_dwordx2 s[44:45], s[32:35], s14 offset:60
    s_buffer_load_dwordx2 s[44:45], s[32:35], s14 offset:316
    s_buffer_load_dwordx2 s[44:45], s[32:35], s14 offset:2108
    s_buffer_load_dwordx2 s[44:45], s[32:35], s14 offset:2364
    s_barrier
    s_and_b32 s81, s72, 1
    s_lshl_b32 s26, s81, 17
    s_lshl_b32 s86, s77, 7
    s_add_u32 s86, s86, 4194304
    s_add_u32 s26, s26, s86
    s_lshl_b32 s85, s78, 6
    s_add_u32 s26, s26, s85
    v_mul_u32_u24 v4, 278528, v2
    v_lshl_add_u32 v30, v3, 4, v4
    s_or_b32 s81, s81, s78
    s_cmp_lg_u32 s81, 0
    s_cbranch_scc1 vo_16
    s_add_u32 s86, s86, 262144
    buffer_store_dwordx4 v[64:67], v30, s[64:67], s86 offen sc1
vo_16:
    s_add_u32 s86, s26, 0
    buffer_store_dwordx4 v[32:35], v30, s[64:67], s86 offen sc1
    s_add_u32 s86, s26, 16384
    buffer_store_dwordx4 v[36:39], v30, s[64:67], s86 offen sc1
    s_add_u32 s86, s26, 32768
    buffer_store_dwordx4 v[40:43], v30, s[64:67], s86 offen sc1
    s_add_u32 s86, s26, 49152
    buffer_store_dwordx4 v[44:47], v30, s[64:67], s86 offen sc1
    s_add_u32 s86, s26, 65536
    buffer_store_dwordx4 v[48:51], v30, s[64:67], s86 offen sc1
    s_add_u32 s86, s26, 81920
    buffer_store_dwordx4 v[52:55], v30, s[64:67], s86 offen sc1
    s_add_u32 s86, s26, 98304
    buffer_store_dwordx4 v[56:59], v30, s[64:67], s86 offen sc1
    s_add_u32 s86, s26, 114688
    buffer_store_dwordx4 v[60:63], v30, s[64:67], s86 offen sc1
    s_buffer_load_dwordx2 s[44:45], s[32:35], s14 offset:4156
    s_buffer_load_dwordx2 s[44:45], s[32:35], s14 offset:4412
    s_buffer_load_dwordx2 s[44:45], s[28:31], s12 offset:1596
    s_buffer_load_dwordx2 s[44:45], s[28:31], s12 offset:5692
    s_buffer_load_dwordx2 s[44:45], s[28:31], s12 offset:9788
    s_buffer_load_dwordx2 s[44:45], s[28:31], s12 offset:13884
    s_add_u32 s14, s19, 4718592
    s_buffer_load_dwordx2 s[44:45], s[32:35], s14 offset:60
    s_barrier
    s_buffer_load_dwordx2 s[44:45], s[32:35], s14 offset:2108
    s_add_u32 s14, s13, 5111808
    s_buffer_load_dwordx2 s[44:45], s[32:35], s14 offset:60
    s_buffer_load_dwordx2 s[44:45], s[32:35], s14 offset:316
    s_buffer_load_dwordx2 s[44:45], s[32:35], s14 offset:2108
    s_buffer_load_dwordx2 s[44:45], s[32:35], s14 offset:2364
    s_buffer_load_dwordx2 s[44:45], s[32:35], s14 offset:4156
    s_buffer_load_dwordx2 s[44:45], s[32:35], s14 offset:4412
    s_barrier
    s_waitcnt vmcnt(0)
    s_cmp_lg_u32 s72, 7
    s_cbranch_scc1 only_17
spin_18:
    buffer_load_dword v8, v187, s[68:71], 0 offen sc1
    s_waitcnt vmcnt(0)
    v_cmp_ne_u32 vcc, 1, v8
    s_nop 1
    s_cmp_lg_u64 vcc, 0
    s_cbranch_scc1 spin_18
only_17:
    s_buffer_load_dwordx2 s[44:45], s[28:31], s12 offset:1724
    s_buffer_load_dwordx2 s[44:45], s[28:31], s12 offset:5820
    s_buffer_load_dwordx2 s[44:45], s[28:31], s12 offset:9916
    s_buffer_load_dwordx2 s[44:45], s[28:31], s12 offset:14012
    s_add_u32 s14, s19, 5111808
    s_buffer_load_dwordx2 s[44:45], s[32:35], s14 offset:60
    s_buffer_load_dwordx2 s[44:45], s[32:35], s14 offset:2108
    s_add_u32 s14, s13, 5505024
    s_buffer_load_dwordx2 s[44:45], s[32:35], s14 offset:60
    s_barrier
    s_cmp_lg_u32 s72, 7
    s_cbranch_scc1 only_19
    s_lshl_b32 s81, s2, 2
    s_add_u32 s81, s81, 9502720
    v_mov_b32 v4, 0
    v_mov_b32 v5, 1
    s_mov_b64 exec, 1
    buffer_store_dword v5, v4, s[64:67], s81 offen sc1
    s_mov_b64 exec, -1
fl_20:
only_19:
    s_buffer_load_dwordx2 s[44:45], s[32:35], s14 offset:316
    s_buffer_load_dwordx2 s[44:45], s[32:35], s14 offset:2108
    s_buffer_load_dwordx2 s[44:45], s[32:35], s14 offset:2364
    s_buffer_load_dwordx2 s[44:45], s[32:35], s14 offset:4156
    s_buffer_load_dwordx2 s[44:45], s[32:35], s14 offset:4412
    s_buffer_load_dwordx2 s[44:45], s[28:31], s12 offset:1852
    s_buffer_load_dwordx2 s[44:45], s[28:31], s12 offset:5948
    s_barrier
    s_buffer_load_dwordx2 s[44:45], s[28:31], s12 offset:10044
    s_buffer_load_dwordx2 s[44:45], s[28:31], s12 offset:14140
    s_add_u32 s14, s19, 5505024
    s_buffer_load_dwordx2 s[44:45], s[32:35], s14 offset:60
    s_buffer_load_dwordx2 s[44:45], s[32:35], s14 offset:2108
    s_add_u32 s14, s13, 5898240
    s_buffer_load_dwordx2 s[44:45], s[32:35], s14 offset:60
    s_buffer_load_dwordx2 s[44:45], s[32:35], s14 offset:316
    s_buffer_load_dwordx2 s[44:45], s[32:35], s14 offset:2108
    s_barrier
    s_buffer_load_dwordx2 s[44:45], s[32:35], s14 offset:2364
    s_buffer_load_dwordx2 s[44:45], s[32:35], s14 offset:4156
    s_buffer_load_dwordx2 s[44:45], s[32:35], s14 offset:4412
    s_buffer_load_dwordx2 s[44:45], s[28:31], s12 offset:1980
    s_buffer_load_dwordx2 s[44:45], s[28:31], s12 offset:6076
    s_buffer_load_dwordx2 s[44:45], s[28:31], s12 offset:10172
    s_buffer_load_dwordx2 s[44:45], s[28:31], s12 offset:14268
    s_barrier
    s_add_u32 s14, s19, 5898240
    s_buffer_load_dwordx2 s[44:45], s[32:35], s14 offset:60
    s_buffer_load_dwordx2 s[44:45], s[32:35], s14 offset:2108
    s_barrier
    s_mov_b32 s88, 9502720
    s_cmp_lg_u32 s72, 7
    s_cbranch_scc1 only_21
spin_22:
    buffer_load_dwordx4 v[8:11], v232, s[64:67], s88 offen sc1
    s_waitcnt vmcnt(0)
    v_and_b32 v8, v8, v9
    v_and_b32 v10, v10, v11
    v_and_b32 v8, v8, v10
    v_cmp_ne_u32 vcc, 1, v8
    s_nop 1
    s_cmp_lg_u64 vcc, 0
    s_cbranch_scc1 spin_22
only_21:
    s_barrier
    s_cmp_lg_u32 s72, 7
    s_cbranch_scc1 only_23
    s_lshl_b32 s81, s2, 13
    buffer_load_dword v184, v183, s[36:39], s81 offen
only_23:
    s_mul_i32 s81, s16, 17
    s_add_u32 s81, s81, s17
    s_lshl_b32 s81, s81, 14
    s_and_b32 s84, s72, 1
    s_lshl_b32 s82, s84, 13
    s_add_u32 s81, s81, s82
    s_add_u32 s81, s81, 4194304
    s_add_u32 s85, s81, 4096
    s_add_u32 s82, s81, 16384
    v_lshlrev_b32 v4, 7, v1
    buffer_load_dwordx4 v[32:35], v232, s[64:67], s81 offen offset:0 sc1
    buffer_load_dwordx4 v[36:39], v232, s[64:67], s81 offen offset:1024 sc1
    buffer_load_dwordx4 v[40:43], v232, s[64:67], s81 offen offset:2048 sc1
    buffer_load_dwordx4 v[44:47], v232, s[64:67], s81 offen offset:3072 sc1
    buffer_load_dwordx4 v[48:51], v232, s[64:67], s85 offen offset:0 sc1
    buffer_load_dwordx4 v[52:55], v232, s[64:67], s85 offen offset:1024 sc1
    buffer_load_dwordx4 v[56:59], v232, s[64:67], s85 offen offset:2048 sc1
    buffer_load_dwordx4 v[60:63], v232, s[64:67], s85 offen offset:3072 sc1
    buffer_load_dwordx4 v[64:67], v4, s[64:67], s82 offen sc1
    v_lshrrev_b32 v4, 3, v2
    v_and_b32 v5, 1, v3
    v_lshl_add_u32 v4, v5, 1, v4
    v_lshlrev_b32 v4, 5, v4
    v_and_b32 v5, 3, v2
    v_lshl_add_u32 v4, v5, 3, v4
    v_lshrrev_b32 v5, 2, v2
    v_lshl_add_u32 v5, v3, 2, v5
    v_lshl_add_u32 v4, v5, 7, v4
    s_lshr_b32 s82, s72, 2
    s_lshl_b32 s83, s82, 16
    v_add_u32 v228, s83, v4
    v_xor_b32 v229, 32, v228
    v_xor_b32 v230, 64, v228
    v_xor_b32 v231, 96, v228
    s_and_b32 s81, s72, 3
    s_lshl_b32 s81, s81, 1
    s_lshl_b32 s83, s75, 3
    s_add_u32 s81, s81, s83
    s_lshl_b32 s81, s81, 15
    s_lshl_b32 s82, s82, 14
    s_add_u32 s95, s81, s82
    v_lshlrev_b32 v232, 4, v1
    v_add_u32 v233, 0x8000, v232
    s_mov_b32 s93, s80
    s_barrier
    s_branch L_bg
L_ld:
    s_and_b32 s81, s2, 1
    s_bfe_u32 s82, s2, 0x20001
    s_lshr_b32 s83, s2, 3
    s_lshl_b32 s12, s81, 10
    s_lshl_b32 s85, s82, 8
    s_add_u32 s12, s12, s85
    s_lshl_b32 s85, s83, 3
    s_add_u32 s12, s12, s85
    s_lshl_b32 s12, s12, 11
    s_lshl_b32 s13, s81, 5
    s_add_u32 s13, s13, s83
    s_mul_i32 s13, s13, 6144
    s_lshl_b32 s85, s82, 9
    s_add_u32 s13, s13, s85
    s_lshl_b32 s15, s2, 13
    s_xor_b32 s81, s81, 1
    s_lshl_b32 s19, s81, 5
    s_add_u32 s19, s19, s83
    s_mul_i32 s19, s19, 6144
    s_add_u32 s19, s19, s85
    s_add_u32 s19, s19, 384
    s_barrier
    s_and_b32 s81, s72, 3
    s_lshl_b32 s82, s81, 7
    s_add_u32 s82, s82, s13
    s_lshl_b32 s83, s81, 12
    s_add_u32 s83, s83, s12
    s_min_u32 s81, s81, 2
    s_lshl_b32 s81, s81, 11
    s_add_u32 s81, s81, s19
    s_buffer_load_dwordx2 s[44:45], s[32:35], s82 offset:60
    s_buffer_load_dwordx2 s[44:45], s[32:35], s82 offset:2108
    s_buffer_load_dwordx2 s[44:45], s[32:35], s82 offset:4156
    s_buffer_load_dwordx2 s[44:45], s[28:31], s83 offset:60
    s_buffer_load_dwordx2 s[44:45], s[28:31], s83 offset:2108
    s_buffer_load_dwordx2 s[44:45], s[32:35], s81 offset:60
    s_and_b32 s81, s72, 1
    s_lshl_b32 s94, s81, 10
    s_lshl_b32 s82, s73, 4
    s_add_u32 s82, s82, s81
    s_sub_u32 s82, s82, 2
    s_lshl_b32 s82, s82, 14
    s_lshl_b32 s84, s81, 2
    v_lshrrev_b32 v4, 3, v1
    v_and_b32 v5, 7, v1
    v_xor_b32 v5, s84, v5
    v_xor_b32 v7, v5, v3
    v_lshlrev_b32 v7, 4, v7
    v_lshl_add_u32 v7, v4, 11, v7
    v_add_u32 v180, s82, v7
    v_add_u32 v181, 32768, v180
    v_add_u32 v182, 65536, v180
    v_add_u32 v183, 98304, v180
    v_add_u32 v184, 131072, v180
    v_add_u32 v185, 163840, v180
    v_add_u32 v186, 196608, v180
    v_add_u32 v187, 229376, v180
    v_add_u32 v188, 262144, v180
    s_mul_i32 s83, s81, 49152
    s_lshl_b32 s82, s74, 7
    s_add_u32 s83, s83, s82
    v_mul_u32_u24 v6, 6144, v4
    v_and_b32 v7, 1, v3
    v_lshlrev_b32 v7, 1, v7
    v_xor_b32 v7, v5, v7
    v_lshl_add_u32 v6, v7, 4, v6
    v_add_u32 v189, s83, v6
    v_add_u32 v190, 98304, v189
    v_add_u32 v191, 196608, v189
    v_add_u32 v192, 294912, v189
    v_add_u32 v193, 2048, v189
    v_add_u32 v194, 100352, v189
    v_add_u32 v195, 198656, v189
    v_add_u32 v196, 296960, v189
    v_add_u32 v197, 4096, v189
    v_add_u32 v198, 102400, v189
    v_add_u32 v199, 200704, v189
    v_add_u32 v200, 299008, v189
    s_mov_b32 s90, 0
    s_mov_b32 s93, s79
    v_lshlrev_b32 v5, 1, v3
    v_and_b32 v6, 7, v1
    v_xor_b32 v5, v5, v6
    v_lshlrev_b32 v5, 4, v5
    v_lshrrev_b32 v6, 3, v1
    v_lshl_add_u32 v5, v6, 11, v5
    s_lshl_b32 s81, s76, 7
    v_add_u32 v244, s81, v5
    s_lshl_b32 s91, s93, 7
    s_mul_i32 s92, s93, 393216
    s_add_u32 s93, s93, 1
    s_and_b32 s93, s93, 15
    s_add_u32 s81, s90, s94
    s_add_u32 m0, s81, 18432
    s_nop 0
    buffer_load_dwordx4 v189, s[32:35], s92 offen lds
    s_add_u32 m0, s81, 20480
    s_nop 0
    buffer_load_dwordx4 v190, s[32:35], s92 offen lds
    s_add_u32 m0, s81, 22528
    s_nop 0
    buffer_load_dwordx4 v191, s[32:35], s92 offen lds
    s_add_u32 m0, s81, 24576
    s_nop 0
    buffer_load_dwordx4 v192, s[32:35], s92 offen lds
    s_add_u32 m0, s81, 26624
    s_nop 0
    buffer_load_dwordx4 v193, s[32:35], s92 offen lds
    s_add_u32 m0, s81, 28672
    s_nop 0
    buffer_load_dwordx4 v194, s[32:35], s92 offen lds
    s_add_u32 m0, s81, 30720
    s_nop 0
    buffer_load_dwordx4 v195, s[32:35], s92 offen lds
    s_add_u32 m0, s81, 32768
    s_nop 0
    buffer_load_dwordx4 v196, s[32:35], s92 offen lds
    s_add_u32 m0, s81, 34816
    s_nop 0
    buffer_load_dwordx4 v197, s[32:35], s92 offen lds
    s_add_u32 m0, s81, 36864
    s_nop 0
    buffer_load_dwordx4 v198, s[32:35], s92 offen lds
    s_add_u32 m0, s81, 38912
    s_nop 0
    buffer_load_dwordx4 v199, s[32:35], s92 offen lds
    s_add_u32 m0, s81, 40960
    s_nop 0
    buffer_load_dwordx4 v200, s[32:35], s92 offen lds
    s_add_u32 m0, s81, 0
    s_nop 0
    buffer_load_dwordx4 v180, s[28:31], s91 offen lds
    s_add_u32 m0, s81, 2048
    s_nop 0
    buffer_load_dwordx4 v181, s[28:31], s91 offen lds
    s_add_u32 m0, s81, 4096
    s_nop 0
    buffer_load_dwordx4 v182, s[28:31], s91 offen lds
    s_add_u32 m0, s81, 6144
    s_nop 0
    buffer_load_dwordx4 v183, s[28:31], s91 offen lds
    s_add_u32 m0, s81, 8192
    s_nop 0
    buffer_load_dwordx4 v184, s[28:31], s91 offen lds
    s_add_u32 m0, s81, 10240
    s_nop 0
    buffer_load_dwordx4 v185, s[28:31], s91 offen lds
    s_add_u32 m0, s81, 12288
    s_nop 0
    buffer_load_dwordx4 v186, s[28:31], s91 offen lds
    s_add_u32 m0, s81, 14336
    s_nop 0
    buffer_load_dwordx4 v187, s[28:31], s91 offen lds
    s_add_u32 m0, s81, 16384
    s_nop 0
    buffer_load_dwordx4 v188, s[28:31], s91 offen lds
    s_add_u32 s90, s90, 43008
    s_cmp_eq_u32 s90, 129024
    s_cselect_b32 s90, 0, s90
    s_lshl_b32 s91, s93, 7
    s_mul_i32 s92, s93, 393216
    s_add_u32 s93, s93, 1
    s_and_b32 s93, s93, 15
    s_add_u32 s81, s90, s94
    s_add_u32 m0, s81, 18432
    s_nop 0
    buffer_load_dwordx4 v189, s[32:35], s92 offen lds
    s_add_u32 m0, s81, 20480
    s_nop 0
    buffer_load_dwordx4 v190, s[32:35], s92 offen lds
    s_add_u32 m0, s81, 22528
    s_nop 0
    buffer_load_dwordx4 v191, s[32:35], s92 offen lds
    s_add_u32 m0, s81, 24576
    s_nop 0
    buffer_load_dwordx4 v192, s[32:35], s92 offen lds
    s_add_u32 m0, s81, 26624
    s_nop 0
    buffer_load_dwordx4 v193, s[32:35], s92 offen lds
    s_add_u32 m0, s81, 28672
    s_nop 0
    buffer_load_dwordx4 v194, s[32:35], s92 offen lds
    s_add_u32 m0, s81, 30720
    s_nop 0
    buffer_load_dwordx4 v195, s[32:35], s92 offen lds
    s_add_u32 m0, s81, 32768
    s_nop 0
    buffer_load_dwordx4 v196, s[32:35], s92 offen lds
    s_add_u32 m0, s81, 34816
    s_nop 0
    buffer_load_dwordx4 v197, s[32:35], s92 offen lds
    s_add_u32 m0, s81, 36864
    s_nop 0
    buffer_load_dwordx4 v198, s[32:35], s92 offen lds
    s_waitcnt vmcnt(10)
    s_barrier
    s_add_u32 m0, s81, 38912
    s_nop 0
    buffer_load_dwordx4 v199, s[32:35], s92 offen lds
    s_add_u32 m0, s81, 40960
    s_nop 0
    buffer_load_dwordx4 v200, s[32:35], s92 offen lds
    s_add_u32 m0, s81, 0
    s_nop 0
    buffer_load_dwordx4 v180, s[28:31], s91 offen lds
    s_add_u32 m0, s81, 2048
    s_nop 0
    buffer_load_dwordx4 v181, s[28:31], s91 offen lds
    s_add_u32 m0, s81, 4096
    s_nop 0
    buffer_load_dwordx4 v182, s[28:31], s91 offen lds
    s_add_u32 m0, s81, 6144
    s_nop 0
    buffer_load_dwordx4 v183, s[28:31], s91 offen lds
    s_add_u32 m0, s81, 8192
    s_nop 0
    buffer_load_dwordx4 v184, s[28:31], s91 offen lds
    s_add_u32 m0, s81, 10240
    s_nop 0
    buffer_load_dwordx4 v185, s[28:31], s91 offen lds
    s_add_u32 m0, s81, 12288
    s_nop 0
    buffer_load_dwordx4 v186, s[28:31], s91 offen lds
    s_add_u32 m0, s81, 14336
    s_nop 0
    buffer_load_dwordx4 v187, s[28:31], s91 offen lds
    s_add_u32 m0, s81, 16384
    s_nop 0
    buffer_load_dwordx4 v188, s[28:31], s91 offen lds
    s_add_u32 s90, s90, 43008
    s_cmp_eq_u32 s90, 129024
    s_cselect_b32 s90, 0, s90
    s_lshl_b32 s91, s93, 7
    s_mul_i32 s92, s93, 393216
    s_add_u32 s93, s93, 1
    s_and_b32 s93, s93, 15
    s_add_u32 s81, s90, s94
    s_add_u32 m0, s81, 18432
    s_nop 0
    buffer_load_dwordx4 v189, s[32:35], s92 offen lds
    s_add_u32 m0, s81, 20480
    s_nop 0
    buffer_load_dwordx4 v190, s[32:35], s92 offen lds
    s_add_u32 m0, s81, 22528
    s_nop 0
    buffer_load_dwordx4 v191, s[32:35], s92 offen lds
    s_add_u32 m0, s81, 24576
    s_nop 0
    buffer_load_dwordx4 v192, s[32:35], s92 offen lds
    s_add_u32 m0, s81, 26624
    s_nop 0
    buffer_load_dwordx4 v193, s[32:35], s92 offen lds
    s_add_u32 m0, s81, 28672
    s_nop 0
    buffer_load_dwordx4 v194, s[32:35], s92 offen lds
    s_add_u32 m0, s81, 30720
    s_nop 0
    buffer_load_dwordx4 v195, s[32:35], s92 offen lds
    s_add_u32 m0, s81, 32768
    s_nop 0
    buffer_load_dwordx4 v196, s[32:35], s92 offen lds
    s_add_u32 m0, s81, 34816
    s_nop 0
    buffer_load_dwordx4 v197, s[32:35], s92 offen lds
    s_add_u32 m0, s81, 36864
    s_nop 0
    buffer_load_dwordx4 v198, s[32:35], s92 offen lds
    s_add_u32 m0, s81, 38912
    s_nop 0
    buffer_load_dwordx4 v199, s[32:35], s92 offen lds
    s_add_u32 m0, s81, 40960
    s_nop 0
    buffer_load_dwordx4 v200, s[32:35], s92 offen lds
    v_lshlrev_b32 v4, 2, v2
    v_add_u32 v4, 155648, v4
    v_mov_b32 v5, 0
    ds_write_b32 v4, v5
    s_waitcnt vmcnt(12) lgkmcnt(0)
    s_barrier
    s_add_u32 m0, s81, 0
    s_nop 0
    buffer_load_dwordx4 v180, s[28:31], s91 offen lds
    s_add_u32 m0, s81, 2048
    s_nop 0
    buffer_load_dwordx4 v181, s[28:31], s91 offen lds
    s_add_u32 m0, s81, 4096
    s_nop 0
    buffer_load_dwordx4 v182, s[28:31], s91 offen lds
    s_add_u32 m0, s81, 6144
    s_nop 0
    buffer_load_dwordx4 v183, s[28:31], s91 offen lds
    s_add_u32 m0, s81, 8192
    s_nop 0
    buffer_load_dwordx4 v184, s[28:31], s91 offen lds
    s_add_u32 m0, s81, 10240
    s_nop 0
    buffer_load_dwordx4 v185, s[28:31], s91 offen lds
    s_add_u32 m0, s81, 12288
    s_nop 0
    buffer_load_dwordx4 v186, s[28:31], s91 offen lds
    s_add_u32 m0, s81, 14336
    s_nop 0
    buffer_load_dwordx4 v187, s[28:31], s91 offen lds
    s_add_u32 m0, s81, 16384
    s_nop 0
    buffer_load_dwordx4 v188, s[28:31], s91 offen lds
    s_add_u32 s90, s90, 43008
    s_cmp_eq_u32 s90, 129024
    s_cselect_b32 s90, 0, s90
    s_mov_b32 s89, 0
ld_24:
    s_lshl_b32 s91, s93, 7
    s_mul_i32 s92, s93, 393216
    s_add_u32 s93, s93, 1
    s_and_b32 s93, s93, 15
    s_add_u32 s81, s90, s94
    s_add_u32 m0, s81, 18432
    s_nop 0
    buffer_load_dwordx4 v189, s[32:35], s92 offen lds
    s_add_u32 m0, s81, 20480
    s_nop 0
    buffer_load_dwordx4 v190, s[32:35], s92 offen lds
    s_add_u32 m0, s81, 22528
    s_nop 0
    buffer_load_dwordx4 v191, s[32:35], s92 offen lds
    s_add_u32 m0, s81, 24576
    s_nop 0
    buffer_load_dwordx4 v192, s[32:35], s92 offen lds
    s_add_u32 m0, s81, 26624
    s_nop 0
    buffer_load_dwordx4 v193, s[32:35], s92 offen lds
    s_add_u32 m0, s81, 28672
    s_nop 0
    buffer_load_dwordx4 v194, s[32:35], s92 offen lds
    s_add_u32 m0, s81, 30720
    s_nop 0
    buffer_load_dwordx4 v195, s[32:35], s92 offen lds
    s_add_u32 m0, s81, 32768
    s_nop 0
    buffer_load_dwordx4 v196, s[32:35], s92 offen lds
    s_add_u32 m0, s81, 34816
    s_nop 0
    buffer_load_dwordx4 v197, s[32:35], s92 offen lds
    s_add_u32 m0, s81, 36864
    s_nop 0
    buffer_load_dwordx4 v198, s[32:35], s92 offen lds
    s_add_u32 m0, s81, 38912
    s_nop 0
    buffer_load_dwordx4 v199, s[32:35], s92 offen lds
    s_add_u32 m0, s81, 40960
    s_nop 0
    buffer_load_dwordx4 v200, s[32:35], s92 offen lds
    s_add_u32 m0, s81, 0
    s_nop 0
    buffer_load_dwordx4 v180, s[28:31], s91 offen lds
    s_add_u32 m0, s81, 2048
    s_nop 0
    buffer_load_dwordx4 v181, s[28:31], s91 offen lds
    s_add_u32 m0, s81, 4096
    s_nop 0
    buffer_load_dwordx4 v182, s[28:31], s91 offen lds
    s_add_u32 m0, s81, 6144
    s_nop 0
    buffer_load_dwordx4 v183, s[28:31], s91 offen lds
    s_add_u32 m0, s81, 8192
    s_nop 0
    buffer_load_dwordx4 v184, s[28:31], s91 offen lds
    s_add_u32 m0, s81, 10240
    s_nop 0
    buffer_load_dwordx4 v185, s[28:31], s91 offen lds
    s_add_u32 m0, s81, 12288
    s_nop 0
    buffer_load_dwordx4 v186, s[28:31], s91 offen lds
    s_add_u32 m0, s81, 14336
    s_nop 0
    buffer_load_dwordx4 v187, s[28:31], s91 offen lds
    s_add_u32 m0, s81, 16384
    s_nop 0
    buffer_load_dwordx4 v188, s[28:31], s91 offen lds
    s_add_u32 s90, s90, 43008
    s_cmp_eq_u32 s90, 129024
    s_cselect_b32 s90, 0, s90
    s_waitcnt vmcnt(21)
    s_barrier
    s_add_u32 s89, s89, 1
    s_cmp_lt_u32 s89, 13
    s_cbranch_scc1 ld_24
    v_lshrrev_b32 v4, 3, v2
    v_and_b32 v5, 1, v3
    v_lshl_add_u32 v4, v5, 1, v4
    v_lshlrev_b32 v4, 5, v4
    v_and_b32 v5, 3, v2
    v_lshl_add_u32 v4, v5, 3, v4
    v_lshrrev_b32 v5, 2, v2
    v_lshl_add_u32 v5, v3, 2, v5
    v_lshl_add_u32 v4, v5, 7, v4
    s_lshr_b32 s82, s72, 2
    s_lshl_b32 s83, s82, 16
    v_add_u32 v228, s83, v4
    v_xor_b32 v229, 32, v228
    v_xor_b32 v230, 64, v228
    v_xor_b32 v231, 96, v228
    s_and_b32 s81, s72, 3
    s_lshl_b32 s81, s81, 1
    s_lshl_b32 s83, s75, 3
    s_add_u32 s81, s81, s83
    s_lshl_b32 s81, s81, 15
    s_lshl_b32 s82, s82, 14
    s_add_u32 s95, s81, s82
    v_lshlrev_b32 v232, 4, v1
    v_add_u32 v233, 0x8000, v232
    s_mov_b32 s93, s80
    s_waitcnt vmcnt(0)
    s_barrier
L_bg:
    s_add_u32 s81, s72, 38
wo_25:
    s_lshr_b32 s82, s81, 2
    s_add_u32 s82, s82, s80
    s_and_b32 s82, s82, 15
    s_lshl_b32 s82, s82, 2
    s_and_b32 s83, s81, 0x43
    s_or_b32 s82, s82, s83
    s_lshl_b32 m0, s81, 10
    s_lshl_b32 s82, s82, 14
    buffer_load_dwordx4 v244, s[36:39], s82 offen lds
    s_add_u32 s81, s81, 4
    s_cmp_lt_u32 s81, 128
    s_cbranch_scc1 wo_25
    s_cmp_lt_u32 s72, 6
    s_cbranch_scc1 vl_26
    s_waitcnt vmcnt(21)
    s_and_b32 s84, s72, 1
    s_lshl_b32 s81, s84, 13
    v_and_b32 v6, 1, v3
    v_xor_b32 v6, v6, v1
    v_lshlrev_b32 v6, 4, v6
    s_add_u32 s81, s81, 131072
    v_add_u32 v6, s81, v6
    s_lshl_b32 s81, s84, 10
    s_add_u32 s81, s81, 147456
    v_add_u32 v7, s81, v232
    ds_write_b128 v6, v[32:35] offset:0
    ds_write_b128 v6, v[36:39] offset:1024
    ds_write_b128 v6, v[40:43] offset:2048
    ds_write_b128 v6, v[44:47] offset:3072
    ds_write_b128 v6, v[48:51] offset:4096
    ds_write_b128 v6, v[52:55] offset:5120
    ds_write_b128 v6, v[56:59] offset:6144
    ds_write_b128 v6, v[60:63] offset:7168
    ds_write_b128 v7, v[64:67]
    s_waitcnt lgkmcnt(0)
    v_mov_b32 v4, 155652
    v_mov_b32 v5, 1
    s_mov_b64 exec, 1
    ds_add_u32 v4, v5
    s_mov_b64 exec, -1
vl_26:
    s_lshl_b32 s87, s72, 8
    s_add_u32 s87, s87, s16
    v_lshl_add_u32 v14, v2, 4, s87
    v_cvt_f32_u32 v14, v14
    v_mul_f32 v14, 0x3a000000, v14
    v_lshlrev_b32 v15, 3, v3
    v_cvt_f32_u32 v15, v15
    v_mul_f32 v15, v15, v14
    v_mul_f32 v8, 0x42000000, v14
    v_cos_f32 v212, v8
    v_sin_f32 v214, v8
    v_cos_f32 v192, v15
    v_sin_f32 v200, v15
    v_add_f32 v15, v15, v14
    v_cos_f32 v193, v15
    v_sin_f32 v201, v15
    v_add_f32 v15, v15, v14
    v_cos_f32 v194, v15
    v_sin_f32 v202, v15
    v_add_f32 v15, v15, v14
    v_cos_f32 v195, v15
    v_sin_f32 v203, v15
    v_add_f32 v15, v15, v14
    v_cos_f32 v196, v15
    v_sin_f32 v204, v15
    v_add_f32 v15, v15, v14
    v_cos_f32 v197, v15
    v_sin_f32 v205, v15
    v_add_f32 v15, v15, v14
    v_cos_f32 v198, v15
    v_sin_f32 v206, v15
    v_add_f32 v15, v15, v14
    v_cos_f32 v199, v15
    v_sin_f32 v207, v15
    v_cvt_pk_bf16_f32 v144, v192, v193
    v_cvt_pk_bf16_f32 v160, -v200, -v201
    v_cvt_pk_bf16_f32 v145, v194, v195
    v_cvt_pk_bf16_f32 v161, -v202, -v203
    v_cvt_pk_bf16_f32 v146, v196, v197
    v_cvt_pk_bf16_f32 v162, -v204, -v205
    v_cvt_pk_bf16_f32 v147, v198, v199
    v_cvt_pk_bf16_f32 v163, -v206, -v207
    v_pk_mul_f32 v[208:209], v[192:193], v[212:213] op_sel_hi:[1,0]
    v_pk_mul_f32 v[210:211], v[192:193], v[214:215] op_sel_hi:[1,0]
    v_pk_fma_f32 v[192:193], v[200:201], v[214:215], v[208:209] op_sel_hi:[1,0,1] neg_lo:[1,0,0] neg_hi:[1,0,0]
    v_pk_fma_f32 v[200:201], v[200:201], v[212:213], v[210:211] op_sel_hi:[1,0,1]
    v_pk_mul_f32 v[208:209], v[194:195], v[212:213] op_sel_hi:[1,0]
    v_pk_mul_f32 v[210:211], v[194:195], v[214:215] op_sel_hi:[1,0]
    v_pk_fma_f32 v[194:195], v[202:203], v[214:215], v[208:209] op_sel_hi:[1,0,1] neg_lo:[1,0,0] neg_hi:[1,0,0]
    v_pk_fma_f32 v[202:203], v[202:203], v[212:213], v[210:211] op_sel_hi:[1,0,1]
    v_pk_mul_f32 v[208:209], v[196:197], v[212:213] op_sel_hi:[1,0]
    v_pk_mul_f32 v[210:211], v[196:197], v[214:215] op_sel_hi:[1,0]
    v_pk_fma_f32 v[196:197], v[204:205], v[214:215], v[208:209] op_sel_hi:[1,0,1] neg_lo:[1,0,0] neg_hi:[1,0,0]
    v_pk_fma_f32 v[204:205], v[204:205], v[212:213], v[210:211] op_sel_hi:[1,0,1]
    v_pk_mul_f32 v[208:209], v[198:199], v[212:213] op_sel_hi:[1,0]
    v_pk_mul_f32 v[210:211], v[198:199], v[214:215] op_sel_hi:[1,0]
    v_pk_fma_f32 v[198:199], v[206:207], v[214:215], v[208:209] op_sel_hi:[1,0,1] neg_lo:[1,0,0] neg_hi:[1,0,0]
    v_pk_fma_f32 v[206:207], v[206:207], v[212:213], v[210:211] op_sel_hi:[1,0,1]
    v_cvt_pk_bf16_f32 v148, v192, v193
    v_cvt_pk_bf16_f32 v164, -v200, -v201
    v_cvt_pk_bf16_f32 v149, v194, v195
    v_cvt_pk_bf16_f32 v165, -v202, -v203
    v_cvt_pk_bf16_f32 v150, v196, v197
    v_cvt_pk_bf16_f32 v166, -v204, -v205
    v_cvt_pk_bf16_f32 v151, v198, v199
    v_cvt_pk_bf16_f32 v167, -v206, -v207
    v_pk_mul_f32 v[208:209], v[192:193], v[212:213] op_sel_hi:[1,0]
    v_pk_mul_f32 v[210:211], v[192:193], v[214:215] op_sel_hi:[1,0]
    v_pk_fma_f32 v[192:193], v[200:201], v[214:215], v[208:209] op_sel_hi:[1,0,1] neg_lo:[1,0,0] neg_hi:[1,0,0]
    v_pk_fma_f32 v[200:201], v[200:201], v[212:213], v[210:211] op_sel_hi:[1,0,1]
    v_pk_mul_f32 v[208:209], v[194:195], v[212:213] op_sel_hi:[1,0]
    v_pk_mul_f32 v[210:211], v[194:195], v[214:215] op_sel_hi:[1,0]
    v_pk_fma_f32 v[194:195], v[202:203], v[214:215], v[208:209] op_sel_hi:[1,0,1] neg_lo:[1,0,0] neg_hi:[1,0,0]
    v_pk_fma_f32 v[202:203], v[202:203], v[212:213], v[210:211] op_sel_hi:[1,0,1]
    v_pk_mul_f32 v[208:209], v[196:197], v[212:213] op_sel_hi:[1,0]
    v_pk_mul_f32 v[210:211], v[196:197], v[214:215] op_sel_hi:[1,0]
    v_pk_fma_f32 v[196:197], v[204:205], v[214:215], v[208:209] op_sel_hi:[1,0,1] neg_lo:[1,0,0] neg_hi:[1,0,0]
    v_pk_fma_f32 v[204:205], v[204:205], v[212:213], v[210:211] op_sel_hi:[1,0,1]
    v_pk_mul_f32 v[208:209], v[198:199], v[212:213] op_sel_hi:[1,0]
    v_pk_mul_f32 v[210:211], v[198:199], v[214:215] op_sel_hi:[1,0]
    v_pk_fma_f32 v[198:199], v[206:207], v[214:215], v[208:209] op_sel_hi:[1,0,1] neg_lo:[1,0,0] neg_hi:[1,0,0]
    v_pk_fma_f32 v[206:207], v[206:207], v[212:213], v[210:211] op_sel_hi:[1,0,1]
    v_cvt_pk_bf16_f32 v152, v192, v193
    v_cvt_pk_bf16_f32 v168, -v200, -v201
    v_cvt_pk_bf16_f32 v153, v194, v195
    v_cvt_pk_bf16_f32 v169, -v202, -v203
    v_cvt_pk_bf16_f32 v154, v196, v197
    v_cvt_pk_bf16_f32 v170, -v204, -v205
    v_cvt_pk_bf16_f32 v155, v198, v199
    v_cvt_pk_bf16_f32 v171, -v206, -v207
    v_pk_mul_f32 v[208:209], v[192:193], v[212:213] op_sel_hi:[1,0]
    v_pk_mul_f32 v[210:211], v[192:193], v[214:215] op_sel_hi:[1,0]
    v_pk_fma_f32 v[192:193], v[200:201], v[214:215], v[208:209] op_sel_hi:[1,0,1] neg_lo:[1,0,0] neg_hi:[1,0,0]
    v_pk_fma_f32 v[200:201], v[200:201], v[212:213], v[210:211] op_sel_hi:[1,0,1]
    v_pk_mul_f32 v[208:209], v[194:195], v[212:213] op_sel_hi:[1,0]
    v_pk_mul_f32 v[210:211], v[194:195], v[214:215] op_sel_hi:[1,0]
    v_pk_fma_f32 v[194:195], v[202:203], v[214:215], v[208:209] op_sel_hi:[1,0,1] neg_lo:[1,0,0] neg_hi:[1,0,0]
    v_pk_fma_f32 v[202:203], v[202:203], v[212:213], v[210:211] op_sel_hi:[1,0,1]
    v_pk_mul_f32 v[208:209], v[196:197], v[212:213] op_sel_hi:[1,0]
    v_pk_mul_f32 v[210:211], v[196:197], v[214:215] op_sel_hi:[1,0]
    v_pk_fma_f32 v[196:197], v[204:205], v[214:215], v[208:209] op_sel_hi:[1,0,1] neg_lo:[1,0,0] neg_hi:[1,0,0]
    v_pk_fma_f32 v[204:205], v[204:205], v[212:213], v[210:211] op_sel_hi:[1,0,1]
    v_pk_mul_f32 v[208:209], v[198:199], v[212:213] op_sel_hi:[1,0]
    v_pk_mul_f32 v[210:211], v[198:199], v[214:215] op_sel_hi:[1,0]
    v_pk_fma_f32 v[198:199], v[206:207], v[214:215], v[208:209] op_sel_hi:[1,0,1] neg_lo:[1,0,0] neg_hi:[1,0,0]
    v_pk_fma_f32 v[206:207], v[206:207], v[212:213], v[210:211] op_sel_hi:[1,0,1]
    v_cvt_pk_bf16_f32 v156, v192, v193
    v_cvt_pk_bf16_f32 v172, -v200, -v201
    v_cvt_pk_bf16_f32 v157, v194, v195
    v_cvt_pk_bf16_f32 v173, -v202, -v203
    v_cvt_pk_bf16_f32 v158, v196, v197
    v_cvt_pk_bf16_f32 v174, -v204, -v205
    v_cvt_pk_bf16_f32 v159, v198, v199
    v_cvt_pk_bf16_f32 v175, -v206, -v207
    v_mov_b32 v4, 155664
lw_27:
    s_sleep 1
    ds_read_b32 v6, v4
    s_waitcnt lgkmcnt(0)
    v_readfirstlane_b32 s81, v6
    s_nop 1
    s_cmp_lt_u32 s81, 4
    s_cbranch_scc1 lw_27
    s_sub_u32 s81, s72, 4
wo_28:
    s_lshr_b32 s82, s81, 2
    s_add_u32 s82, s82, s80
    s_and_b32 s82, s82, 15
    s_lshl_b32 s82, s82, 2
    s_and_b32 s83, s81, 0x43
    s_or_b32 s82, s82, s83
    s_lshl_b32 m0, s81, 10
    s_lshl_b32 s82, s82, 14
    buffer_load_dwordx4 v244, s[36:39], s82 offen lds
    s_add_u32 s81, s81, 4
    s_cmp_lt_u32 s81, 42
    s_cbranch_scc1 wo_28
    v_lshrrev_b32 v10, 2, v2
    v_lshl_add_u32 v10, v3, 3, v10
    v_and_b32 v9, 1, v3
    v_lshlrev_b32 v9, 3, v9
    v_lshl_add_u32 v12, v10, 4, v9
    v_add_u32 v240, 147456, v12
    v_xor_b32 v241, 8, v240
    v_lshl_add_u32 v10, v10, 7, v9
    v_and_b32 v11, 3, v2
    v_lshl_add_u32 v10, v11, 5, v10
    v_lshrrev_b32 v11, 3, v2
    v_lshl_add_u32 v10, v11, 4, v10
    v_add_u32 v236, 131072, v10
    v_xor_b32 v237, 8, v236
    v_xor_b32 v238, 16, v236
    v_xor_b32 v239, 24, v236
    s_lshl_b32 s81, s72, 8
    s_add_u32 s81, s81, s16
    v_lshl_add_u32 v14, v2, 4, s81
    v_lshlrev_b32 v6, 4, v3
    s_lshl_b32 s81, s17, 6
    s_add_u32 s85, s81, 2048
    s_sub_u32 s83, 4080, s81
    v_sub_u32 v8, 2048, v14
    v_and_b32 v8, 2047, v8
    v_lshlrev_b32 v8, 12, v8
    v_sub_u32 v8, v8, v6
    v_add_u32 v184, s83, v8
    v_lshl_add_u32 v14, v14, 12, v6
    v_add_u32 v185, s85, v14
    v_add_u32 v9, 16, v1
    v_lshlrev_b32 v186, 2, v9
    v_mov_b32 v4, 155652
lw_29:
    ds_read_b32 v6, v4
    s_waitcnt lgkmcnt(0)
    v_readfirstlane_b32 s81, v6
    s_nop 1
    s_cmp_lt_u32 s81, 2
    s_cbranch_scc1 lw_29
    ds_read_b64_tr_b16 v[192:193], v236 offset:0
    ds_read_b64_tr_b16 v[194:195], v236 offset:512
    ds_read_b64_tr_b16 v[196:197], v238 offset:0
    ds_read_b64_tr_b16 v[198:199], v238 offset:512
    ds_read_b64_tr_b16 v[200:201], v240 offset:0
    ds_read_b64_tr_b16 v[202:203], v240 offset:64
    ds_read_b64_tr_b16 v[204:205], v236 offset:4096
    ds_read_b64_tr_b16 v[206:207], v236 offset:4608
    ds_read_b64_tr_b16 v[208:209], v238 offset:4096
    ds_read_b64_tr_b16 v[210:211], v238 offset:4608
    ds_read_b64_tr_b16 v[212:213], v240 offset:512
    ds_read_b64_tr_b16 v[214:215], v240 offset:576
    ds_read_b64_tr_b16 v[216:217], v236 offset:8192
    ds_read_b64_tr_b16 v[218:219], v236 offset:8704
    ds_read_b64_tr_b16 v[220:221], v238 offset:8192
    ds_read_b64_tr_b16 v[222:223], v238 offset:8704
    ds_read_b64_tr_b16 v[224:225], v240 offset:1024
    ds_read_b64_tr_b16 v[226:227], v240 offset:1088
    s_waitcnt lgkmcnt(12)
    v_mfma_f32_16x16x32_bf16 v[80:83], v[192:195], v[144:147], 0
    v_mfma_f32_16x16x32_bf16 v[84:87], v[196:199], v[144:147], 0
    v_mfma_f32_16x16x32_bf16 v[88:91], v[200:203], v[144:147], 0
    ds_read_b64_tr_b16 v[192:193], v236 offset:12288
    ds_read_b64_tr_b16 v[194:195], v236 offset:12800
    ds_read_b64_tr_b16 v[196:197], v238 offset:12288
    ds_read_b64_tr_b16 v[198:199], v238 offset:12800
    ds_read_b64_tr_b16 v[200:201], v240 offset:1536
    ds_read_b64_tr_b16 v[202:203], v240 offset:1600
    s_waitcnt lgkmcnt(12)
    v_mfma_f32_16x16x32_bf16 v[80:83], v[204:207], v[148:151], v[80:83]
    v_mfma_f32_16x16x32_bf16 v[84:87], v[208:211], v[148:151], v[84:87]
    v_mfma_f32_16x16x32_bf16 v[88:91], v[212:215], v[148:151], v[88:91]
    ds_read_b64_tr_b16 v[204:205], v237 offset:0
    ds_read_b64_tr_b16 v[206:207], v237 offset:512
    ds_read_b64_tr_b16 v[208:209], v239 offset:0
    ds_read_b64_tr_b16 v[210:211], v239 offset:512
    ds_read_b64_tr_b16 v[212:213], v241 offset:0
    ds_read_b64_tr_b16 v[214:215], v241 offset:64
    s_waitcnt lgkmcnt(12)
    v_mfma_f32_16x16x32_bf16 v[80:83], v[216:219], v[152:155], v[80:83]
    v_mfma_f32_16x16x32_bf16 v[84:87], v[220:223], v[152:155], v[84:87]
    v_mfma_f32_16x16x32_bf16 v[88:91], v[224:227], v[152:155], v[88:91]
    ds_read_b64_tr_b16 v[216:217], v237 offset:4096
    ds_read_b64_tr_b16 v[218:219], v237 offset:4608
    ds_read_b64_tr_b16 v[220:221], v239 offset:4096
    ds_read_b64_tr_b16 v[222:223], v239 offset:4608
    ds_read_b64_tr_b16 v[224:225], v241 offset:512
    ds_read_b64_tr_b16 v[226:227], v241 offset:576
    s_waitcnt lgkmcnt(12)
    v_mfma_f32_16x16x32_bf16 v[80:83], v[192:195], v[156:159], v[80:83]
    v_mfma_f32_16x16x32_bf16 v[84:87], v[196:199], v[156:159], v[84:87]
    v_mfma_f32_16x16x32_bf16 v[88:91], v[200:203], v[156:159], v[88:91]
    ds_read_b64_tr_b16 v[192:193], v237 offset:8192
    ds_read_b64_tr_b16 v[194:195], v237 offset:8704
    ds_read_b64_tr_b16 v[196:197], v239 offset:8192
    ds_read_b64_tr_b16 v[198:199], v239 offset:8704
    ds_read_b64_tr_b16 v[200:201], v241 offset:1024
    ds_read_b64_tr_b16 v[202:203], v241 offset:1088
    s_waitcnt lgkmcnt(12)
    v_mfma_f32_16x16x32_bf16 v[80:83], v[204:207], v[160:163], v[80:83]
    v_mfma_f32_16x16x32_bf16 v[84:87], v[208:211], v[160:163], v[84:87]
    v_mfma_f32_16x16x32_bf16 v[88:91], v[212:215], v[160:163], v[88:91]
    ds_read_b64_tr_b16 v[204:205], v237 offset:12288
    ds_read_b64_tr_b16 v[206:207], v237 offset:12800
    ds_read_b64_tr_b16 v[208:209], v239 offset:12288
    ds_read_b64_tr_b16 v[210:211], v239 offset:12800
    ds_read_b64_tr_b16 v[212:213], v241 offset:1536
    ds_read_b64_tr_b16 v[214:215], v241 offset:1600
    s_waitcnt lgkmcnt(12)
    v_mfma_f32_16x16x32_bf16 v[80:83], v[216:219], v[164:167], v[80:83]
    v_mfma_f32_16x16x32_bf16 v[84:87], v[220:223], v[164:167], v[84:87]
    v_mfma_f32_16x16x32_bf16 v[88:91], v[224:227], v[164:167], v[88:91]
    s_waitcnt lgkmcnt(6)
    v_mfma_f32_16x16x32_bf16 v[80:83], v[192:195], v[168:171], v[80:83]
    v_mfma_f32_16x16x32_bf16 v[84:87], v[196:199], v[168:171], v[84:87]
    v_mfma_f32_16x16x32_bf16 v[88:91], v[200:203], v[168:171], v[88:91]
    s_waitcnt lgkmcnt(0)
    v_mfma_f32_16x16x32_bf16 v[80:83], v[204:207], v[172:175], v[80:83]
    v_mfma_f32_16x16x32_bf16 v[84:87], v[208:211], v[172:175], v[84:87]
    v_mfma_f32_16x16x32_bf16 v[88:91], v[212:215], v[172:175], v[88:91]
    s_nop 5
    ds_bpermute_b32 v15, v186, v80
    v_cmp_eq_u32 vcc, 3, v3
    v_cvt_pk_bf16_f32 v176, v80, v81
    v_cvt_pk_bf16_f32 v177, v82, v83
    v_cvt_pk_bf16_f32 v178, v84, v85
    v_cvt_pk_bf16_f32 v179, v86, v87
    v_cvt_pk_bf16_f32 v181, v86, v85
    v_cvt_pk_bf16_f32 v182, v84, v83
    v_cvt_pk_bf16_f32 v183, v82, v81
    s_waitcnt lgkmcnt(0)
    v_cndmask_b32 v15, v15, v88, vcc
    v_cvt_pk_bf16_f32 v180, v15, v87
    s_waitcnt vmcnt(0)
    s_and_b32 s81, s72, 3
    s_lshl_b32 s84, s81, 12
    v_add_u32 v10, s84, v232
    v_add_u32 v11, 0x10000, v10
    s_lshl_b32 s84, s81, 2
    s_add_u32 s84, s84, 155680
    v_mov_b32 v12, s84
    s_lshl_b32 s81, s81, 1
    s_lshl_b32 s83, s75, 3
    s_add_u32 s81, s81, s83
    s_lshl_b32 s81, s81, 16
    s_lshl_b32 s83, s76, 7
    s_add_u32 s81, s81, s83
    v_and_b32 v8, 1, v3
    v_lshlrev_b32 v8, 5, v8
    v_lshrrev_b32 v9, 1, v3
    v_lshl_add_u32 v8, v9, 4, v8
    v_lshl_add_u32 v8, v2, 12, v8
    v_add_u32 v13, s81, v8
    v_add_u32 v14, 0x10000, v13
    s_barrier
    s_lshl_b32 s87, s93, 10
    s_add_u32 s87, s87, s95
    s_add_u32 s93, s93, 1
    s_and_b32 s93, s93, 15
    buffer_load_dwordx4 v[16:19], v232, s[64:67], s87 offen sc1
    buffer_load_dwordx4 v[20:23], v233, s[64:67], s87 offen sc1
    s_lshl_b32 s87, s93, 10
    s_add_u32 s87, s87, s95
    s_add_u32 s93, s93, 1
    s_and_b32 s93, s93, 15
    buffer_load_dwordx4 v[24:27], v232, s[64:67], s87 offen sc1
    buffer_load_dwordx4 v[28:31], v233, s[64:67], s87 offen sc1
    s_lshl_b32 s87, s93, 10
    s_add_u32 s87, s87, s95
    s_add_u32 s93, s93, 1
    s_and_b32 s93, s93, 15
    buffer_load_dwordx4 v[32:35], v232, s[64:67], s87 offen sc1
    buffer_load_dwordx4 v[36:39], v233, s[64:67], s87 offen sc1
    ds_read_b64_tr_b16 v[112:113], v228 offset:0
    ds_read_b64_tr_b16 v[114:115], v228 offset:2048
    ds_read_b64_tr_b16 v[116:117], v229 offset:0
    ds_read_b64_tr_b16 v[118:119], v229 offset:2048
    ds_read_b64_tr_b16 v[120:121], v230 offset:0
    ds_read_b64_tr_b16 v[122:123], v230 offset:2048
    ds_read_b64_tr_b16 v[124:125], v231 offset:0
    ds_read_b64_tr_b16 v[126:127], v231 offset:2048
    s_waitcnt vmcnt(4) lgkmcnt(0)
    v_mfma_f32_16x16x32_bf16 v[80:83], v[112:115], v[16:19], 0
    ds_read_b64_tr_b16 v[128:129], v228 offset:4096
    s_lshl_b32 s87, s93, 10
    s_add_u32 s87, s87, s95
    s_add_u32 s93, s93, 1
    s_and_b32 s93, s93, 15
    buffer_load_dwordx4 v[40:43], v232, s[64:67], s87 offen sc1
    v_mfma_f32_16x16x32_bf16 v[96:99], v[112:115], v[20:23], 0
    ds_read_b64_tr_b16 v[130:131], v228 offset:6144
    v_mfma_f32_16x16x32_bf16 v[84:87], v[116:119], v[16:19], 0
    ds_read_b64_tr_b16 v[132:133], v229 offset:4096
    v_mfma_f32_16x16x32_bf16 v[100:103], v[116:119], v[20:23], 0
    ds_read_b64_tr_b16 v[134:135], v229 offset:6144
    buffer_load_dwordx4 v[44:47], v233, s[64:67], s87 offen sc1
    v_mfma_f32_16x16x32_bf16 v[88:91], v[120:123], v[16:19], 0
    ds_read_b64_tr_b16 v[136:137], v230 offset:4096
    v_mfma_f32_16x16x32_bf16 v[104:107], v[120:123], v[20:23], 0
    ds_read_b64_tr_b16 v[138:139], v230 offset:6144
    v_mfma_f32_16x16x32_bf16 v[92:95], v[124:127], v[16:19], 0
    ds_read_b64_tr_b16 v[140:141], v231 offset:4096
    v_mfma_f32_16x16x32_bf16 v[108:111], v[124:127], v[20:23], 0
    ds_read_b64_tr_b16 v[142:143], v231 offset:6144
    s_waitcnt vmcnt(4) lgkmcnt(0)
    v_mfma_f32_16x16x32_bf16 v[80:83], v[128:131], v[24:27], v[80:83]
    ds_read_b64_tr_b16 v[112:113], v228 offset:8192
    s_lshl_b32 s87, s93, 10
    s_add_u32 s87, s87, s95
    s_add_u32 s93, s93, 1
    s_and_b32 s93, s93, 15
    buffer_load_dwordx4 v[48:51], v232, s[64:67], s87 offen sc1
    v_mfma_f32_16x16x32_bf16 v[96:99], v[128:131], v[28:31], v[96:99]
    ds_read_b64_tr_b16 v[114:115], v228 offset:10240
    v_mfma_f32_16x16x32_bf16 v[84:87], v[132:135], v[24:27], v[84:87]
    ds_read_b64_tr_b16 v[116:117], v229 offset:8192
    v_mfma_f32_16x16x32_bf16 v[100:103], v[132:135], v[28:31], v[100:103]
    ds_read_b64_tr_b16 v[118:119], v229 offset:10240
    buffer_load_dwordx4 v[52:55], v233, s[64:67], s87 offen sc1
    v_mfma_f32_16x16x32_bf16 v[88:91], v[136:139], v[24:27], v[88:91]
    ds_read_b64_tr_b16 v[120:121], v230 offset:8192
    v_mfma_f32_16x16x32_bf16 v[104:107], v[136:139], v[28:31], v[104:107]
    ds_read_b64_tr_b16 v[122:123], v230 offset:10240
    v_mfma_f32_16x16x32_bf16 v[92:95], v[140:143], v[24:27], v[92:95]
    ds_read_b64_tr_b16 v[124:125], v231 offset:8192
    v_mfma_f32_16x16x32_bf16 v[108:111], v[140:143], v[28:31], v[108:111]
    ds_read_b64_tr_b16 v[126:127], v231 offset:10240
    s_waitcnt vmcnt(4) lgkmcnt(0)
    v_mfma_f32_16x16x32_bf16 v[80:83], v[112:115], v[32:35], v[80:83]
    ds_read_b64_tr_b16 v[128:129], v228 offset:12288
    s_lshl_b32 s87, s93, 10
    s_add_u32 s87, s87, s95
    s_add_u32 s93, s93, 1
    s_and_b32 s93, s93, 15
    buffer_load_dwordx4 v[56:59], v232, s[64:67], s87 offen sc1
    v_mfma_f32_16x16x32_bf16 v[96:99], v[112:115], v[36:39], v[96:99]
    ds_read_b64_tr_b16 v[130:131], v228 offset:14336
    v_mfma_f32_16x16x32_bf16 v[84:87], v[116:119], v[32:35], v[84:87]
    ds_read_b64_tr_b16 v[132:133], v229 offset:12288
    v_mfma_f32_16x16x32_bf16 v[100:103], v[116:119], v[36:39], v[100:103]
    ds_read_b64_tr_b16 v[134:135], v229 offset:14336
    buffer_load_dwordx4 v[60:63], v233, s[64:67], s87 offen sc1
    v_mfma_f32_16x16x32_bf16 v[88:91], v[120:123], v[32:35], v[88:91]
    ds_read_b64_tr_b16 v[136:137], v230 offset:12288
    v_mfma_f32_16x16x32_bf16 v[104:107], v[120:123], v[36:39], v[104:107]
    ds_read_b64_tr_b16 v[138:139], v230 offset:14336
    v_mfma_f32_16x16x32_bf16 v[92:95], v[124:127], v[32:35], v[92:95]
    ds_read_b64_tr_b16 v[140:141], v231 offset:12288
    v_mfma_f32_16x16x32_bf16 v[108:111], v[124:127], v[36:39], v[108:111]
    ds_read_b64_tr_b16 v[142:143], v231 offset:14336
    s_waitcnt vmcnt(4) lgkmcnt(0)
    v_mfma_f32_16x16x32_bf16 v[80:83], v[128:131], v[40:43], v[80:83]
    ds_read_b64_tr_b16 v[112:113], v228 offset:16384
    s_lshl_b32 s87, s93, 10
    s_add_u32 s87, s87, s95
    s_add_u32 s93, s93, 1
    s_and_b32 s93, s93, 15
    buffer_load_dwordx4 v[64:67], v232, s[64:67], s87 offen sc1
    v_mfma_f32_16x16x32_bf16 v[96:99], v[128:131], v[44:47], v[96:99]
    ds_read_b64_tr_b16 v[114:115], v228 offset:18432
    v_mfma_f32_16x16x32_bf16 v[84:87], v[132:135], v[40:43], v[84:87]
    ds_read_b64_tr_b16 v[116:117], v229 offset:16384
    v_mfma_f32_16x16x32_bf16 v[100:103], v[132:135], v[44:47], v[100:103]
    ds_read_b64_tr_b16 v[118:119], v229 offset:18432
    buffer_load_dwordx4 v[68:71], v233, s[64:67], s87 offen sc1
    v_mfma_f32_16x16x32_bf16 v[88:91], v[136:139], v[40:43], v[88:91]
    ds_read_b64_tr_b16 v[120:121], v230 offset:16384
    v_mfma_f32_16x16x32_bf16 v[104:107], v[136:139], v[44:47], v[104:107]
    ds_read_b64_tr_b16 v[122:123], v230 offset:18432
    v_mfma_f32_16x16x32_bf16 v[92:95], v[140:143], v[40:43], v[92:95]
    ds_read_b64_tr_b16 v[124:125], v231 offset:16384
    v_mfma_f32_16x16x32_bf16 v[108:111], v[140:143], v[44:47], v[108:111]
    ds_read_b64_tr_b16 v[126:127], v231 offset:18432
    s_waitcnt vmcnt(4) lgkmcnt(0)
    v_mfma_f32_16x16x32_bf16 v[80:83], v[112:115], v[48:51], v[80:83]
    ds_read_b64_tr_b16 v[128:129], v228 offset:20480
    s_lshl_b32 s87, s93, 10
    s_add_u32 s87, s87, s95
    s_add_u32 s93, s93, 1
    s_and_b32 s93, s93, 15
    buffer_load_dwordx4 v[72:75], v232, s[64:67], s87 offen sc1
    v_mfma_f32_16x16x32_bf16 v[96:99], v[112:115], v[52:55], v[96:99]
    ds_read_b64_tr_b16 v[130:131], v228 offset:22528
    v_mfma_f32_16x16x32_bf16 v[84:87], v[116:119], v[48:51], v[84:87]
    ds_read_b64_tr_b16 v[132:133], v229 offset:20480
    v_mfma_f32_16x16x32_bf16 v[100:103], v[116:119], v[52:55], v[100:103]
    ds_read_b64_tr_b16 v[134:135], v229 offset:22528
    buffer_load_dwordx4 v[76:79], v233, s[64:67], s87 offen sc1
    v_mfma_f32_16x16x32_bf16 v[88:91], v[120:123], v[48:51], v[88:91]
    ds_read_b64_tr_b16 v[136:137], v230 offset:20480
    v_mfma_f32_16x16x32_bf16 v[104:107], v[120:123], v[52:55], v[104:107]
    ds_read_b64_tr_b16 v[138:139], v230 offset:22528
    v_mfma_f32_16x16x32_bf16 v[92:95], v[124:127], v[48:51], v[92:95]
    ds_read_b64_tr_b16 v[140:141], v231 offset:20480
    v_mfma_f32_16x16x32_bf16 v[108:111], v[124:127], v[52:55], v[108:111]
    ds_read_b64_tr_b16 v[142:143], v231 offset:22528
    s_waitcnt vmcnt(4) lgkmcnt(0)
    v_mfma_f32_16x16x32_bf16 v[80:83], v[128:131], v[56:59], v[80:83]
    ds_read_b64_tr_b16 v[112:113], v228 offset:24576
    s_lshl_b32 s87, s93, 10
    s_add_u32 s87, s87, s95
    s_add_u32 s93, s93, 1
    s_and_b32 s93, s93, 15
    buffer_load_dwordx4 v[16:19], v232, s[64:67], s87 offen sc1
    v_mfma_f32_16x16x32_bf16 v[96:99], v[128:131], v[60:63], v[96:99]
    ds_read_b64_tr_b16 v[114:115], v228 offset:26624
    v_mfma_f32_16x16x32_bf16 v[84:87], v[132:135], v[56:59], v[84:87]
    ds_read_b64_tr_b16 v[116:117], v229 offset:24576
    v_mfma_f32_16x16x32_bf16 v[100:103], v[132:135], v[60:63], v[100:103]
    ds_read_b64_tr_b16 v[118:119], v229 offset:26624
    buffer_load_dwordx4 v[20:23], v233, s[64:67], s87 offen sc1
    v_mfma_f32_16x16x32_bf16 v[88:91], v[136:139], v[56:59], v[88:91]
    ds_read_b64_tr_b16 v[120:121], v230 offset:24576
    v_mfma_f32_16x16x32_bf16 v[104:107], v[136:139], v[60:63], v[104:107]
    ds_read_b64_tr_b16 v[122:123], v230 offset:26624
    v_mfma_f32_16x16x32_bf16 v[92:95], v[140:143], v[56:59], v[92:95]
    ds_read_b64_tr_b16 v[124:125], v231 offset:24576
    v_mfma_f32_16x16x32_bf16 v[108:111], v[140:143], v[60:63], v[108:111]
    ds_read_b64_tr_b16 v[126:127], v231 offset:26624
    s_waitcnt vmcnt(4) lgkmcnt(0)
    s_barrier
    v_mfma_f32_16x16x32_bf16 v[80:83], v[112:115], v[64:67], v[80:83]
    ds_read_b64_tr_b16 v[128:129], v228 offset:28672
    s_lshl_b32 s87, s93, 10
    s_add_u32 s87, s87, s95
    s_add_u32 s93, s93, 1
    s_and_b32 s93, s93, 15
    buffer_load_dwordx4 v[24:27], v232, s[64:67], s87 offen sc1
    v_mfma_f32_16x16x32_bf16 v[96:99], v[112:115], v[68:71], v[96:99]
    ds_read_b64_tr_b16 v[130:131], v228 offset:30720
    v_mfma_f32_16x16x32_bf16 v[84:87], v[116:119], v[64:67], v[84:87]
    ds_read_b64_tr_b16 v[132:133], v229 offset:28672
    v_mfma_f32_16x16x32_bf16 v[100:103], v[116:119], v[68:71], v[100:103]
    ds_read_b64_tr_b16 v[134:135], v229 offset:30720
    buffer_load_dwordx4 v[28:31], v233, s[64:67], s87 offen sc1
    v_mfma_f32_16x16x32_bf16 v[88:91], v[120:123], v[64:67], v[88:91]
    ds_read_b64_tr_b16 v[136:137], v230 offset:28672
    v_mfma_f32_16x16x32_bf16 v[104:107], v[120:123], v[68:71], v[104:107]
    ds_read_b64_tr_b16 v[138:139], v230 offset:30720
    v_mfma_f32_16x16x32_bf16 v[92:95], v[124:127], v[64:67], v[92:95]
    ds_read_b64_tr_b16 v[140:141], v231 offset:28672
    v_mfma_f32_16x16x32_bf16 v[108:111], v[124:127], v[68:71], v[108:111]
    ds_read_b64_tr_b16 v[142:143], v231 offset:30720
    s_waitcnt vmcnt(4) lgkmcnt(0)
    v_mfma_f32_16x16x32_bf16 v[80:83], v[128:131], v[72:75], v[80:83]
    ds_read_b64_tr_b16 v[112:113], v228 offset:32768
    s_lshl_b32 s87, s93, 10
    s_add_u32 s87, s87, s95
    s_add_u32 s93, s93, 1
    s_and_b32 s93, s93, 15
    buffer_load_dwordx4 v[32:35], v232, s[64:67], s87 offen sc1
    v_mfma_f32_16x16x32_bf16 v[96:99], v[128:131], v[76:79], v[96:99]
    ds_read_b64_tr_b16 v[114:115], v228 offset:34816
    v_mfma_f32_16x16x32_bf16 v[84:87], v[132:135], v[72:75], v[84:87]
    ds_read_b64_tr_b16 v[116:117], v229 offset:32768
    v_mfma_f32_16x16x32_bf16 v[100:103], v[132:135], v[76:79], v[100:103]
    ds_read_b64_tr_b16 v[118:119], v229 offset:34816
    buffer_load_dwordx4 v[36:39], v233, s[64:67], s87 offen sc1
    v_mfma_f32_16x16x32_bf16 v[88:91], v[136:139], v[72:75], v[88:91]
    ds_read_b64_tr_b16 v[120:121], v230 offset:32768
    v_mfma_f32_16x16x32_bf16 v[104:107], v[136:139], v[76:79], v[104:107]
    ds_read_b64_tr_b16 v[122:123], v230 offset:34816
    v_mfma_f32_16x16x32_bf16 v[92:95], v[140:143], v[72:75], v[92:95]
    ds_read_b64_tr_b16 v[124:125], v231 offset:32768
    v_mfma_f32_16x16x32_bf16 v[108:111], v[140:143], v[76:79], v[108:111]
    ds_read_b64_tr_b16 v[126:127], v231 offset:34816
    s_waitcnt vmcnt(4) lgkmcnt(0)
    v_mfma_f32_16x16x32_bf16 v[80:83], v[112:115], v[16:19], v[80:83]
    ds_read_b64_tr_b16 v[128:129], v228 offset:36864
    s_lshl_b32 s87, s93, 10
    s_add_u32 s87, s87, s95
    s_add_u32 s93, s93, 1
    s_and_b32 s93, s93, 15
    buffer_load_dwordx4 v[40:43], v232, s[64:67], s87 offen sc1
    v_mfma_f32_16x16x32_bf16 v[96:99], v[112:115], v[20:23], v[96:99]
    ds_read_b64_tr_b16 v[130:131], v228 offset:38912
    v_mfma_f32_16x16x32_bf16 v[84:87], v[116:119], v[16:19], v[84:87]
    ds_read_b64_tr_b16 v[132:133], v229 offset:36864
    v_mfma_f32_16x16x32_bf16 v[100:103], v[116:119], v[20:23], v[100:103]
    ds_read_b64_tr_b16 v[134:135], v229 offset:38912
    buffer_load_dwordx4 v[44:47], v233, s[64:67], s87 offen sc1
    v_mfma_f32_16x16x32_bf16 v[88:91], v[120:123], v[16:19], v[88:91]
    ds_read_b64_tr_b16 v[136:137], v230 offset:36864
    v_mfma_f32_16x16x32_bf16 v[104:107], v[120:123], v[20:23], v[104:107]
    ds_read_b64_tr_b16 v[138:139], v230 offset:38912
    v_mfma_f32_16x16x32_bf16 v[92:95], v[124:127], v[16:19], v[92:95]
    ds_read_b64_tr_b16 v[140:141], v231 offset:36864
    v_mfma_f32_16x16x32_bf16 v[108:111], v[124:127], v[20:23], v[108:111]
    ds_read_b64_tr_b16 v[142:143], v231 offset:38912
    s_waitcnt vmcnt(4) lgkmcnt(0)
    v_mfma_f32_16x16x32_bf16 v[80:83], v[128:131], v[24:27], v[80:83]
    ds_read_b64_tr_b16 v[112:113], v228 offset:40960
    s_lshl_b32 s87, s93, 10
    s_add_u32 s87, s87, s95
    s_add_u32 s93, s93, 1
    s_and_b32 s93, s93, 15
    buffer_load_dwordx4 v[48:51], v232, s[64:67], s87 offen sc1
    v_mfma_f32_16x16x32_bf16 v[96:99], v[128:131], v[28:31], v[96:99]
    ds_read_b64_tr_b16 v[114:115], v228 offset:43008
    v_mfma_f32_16x16x32_bf16 v[84:87], v[132:135], v[24:27], v[84:87]
    ds_read_b64_tr_b16 v[116:117], v229 offset:40960
    v_mfma_f32_16x16x32_bf16 v[100:103], v[132:135], v[28:31], v[100:103]
    ds_read_b64_tr_b16 v[118:119], v229 offset:43008
    buffer_load_dwordx4 v[52:55], v233, s[64:67], s87 offen sc1
    v_mfma_f32_16x16x32_bf16 v[88:91], v[136:139], v[24:27], v[88:91]
    ds_read_b64_tr_b16 v[120:121], v230 offset:40960
    v_mfma_f32_16x16x32_bf16 v[104:107], v[136:139], v[28:31], v[104:107]
    ds_read_b64_tr_b16 v[122:123], v230 offset:43008
    v_mfma_f32_16x16x32_bf16 v[92:95], v[140:143], v[24:27], v[92:95]
    ds_read_b64_tr_b16 v[124:125], v231 offset:40960
    v_mfma_f32_16x16x32_bf16 v[108:111], v[140:143], v[28:31], v[108:111]
    ds_read_b64_tr_b16 v[126:127], v231 offset:43008
    s_waitcnt vmcnt(4) lgkmcnt(0)
    v_mfma_f32_16x16x32_bf16 v[80:83], v[112:115], v[32:35], v[80:83]
    ds_read_b64_tr_b16 v[128:129], v228 offset:45056
    s_lshl_b32 s87, s93, 10
    s_add_u32 s87, s87, s95
    s_add_u32 s93, s93, 1
    s_and_b32 s93, s93, 15
    buffer_load_dwordx4 v[56:59], v232, s[64:67], s87 offen sc1
    v_mfma_f32_16x16x32_bf16 v[96:99], v[112:115], v[36:39], v[96:99]
    ds_read_b64_tr_b16 v[130:131], v228 offset:47104
    v_mfma_f32_16x16x32_bf16 v[84:87], v[116:119], v[32:35], v[84:87]
    ds_read_b64_tr_b16 v[132:133], v229 offset:45056
    v_mfma_f32_16x16x32_bf16 v[100:103], v[116:119], v[36:39], v[100:103]
    ds_read_b64_tr_b16 v[134:135], v229 offset:47104
    buffer_load_dwordx4 v[60:63], v233, s[64:67], s87 offen sc1
    v_mfma_f32_16x16x32_bf16 v[88:91], v[120:123], v[32:35], v[88:91]
    ds_read_b64_tr_b16 v[136:137], v230 offset:45056
    v_mfma_f32_16x16x32_bf16 v[104:107], v[120:123], v[36:39], v[104:107]
    ds_read_b64_tr_b16 v[138:139], v230 offset:47104
    v_mfma_f32_16x16x32_bf16 v[92:95], v[124:127], v[32:35], v[92:95]
    ds_read_b64_tr_b16 v[140:141], v231 offset:45056
    v_mfma_f32_16x16x32_bf16 v[108:111], v[124:127], v[36:39], v[108:111]
    ds_read_b64_tr_b16 v[142:143], v231 offset:47104
    s_waitcnt vmcnt(4) lgkmcnt(0)
    v_mfma_f32_16x16x32_bf16 v[80:83], v[128:131], v[40:43], v[80:83]
    ds_read_b64_tr_b16 v[112:113], v228 offset:49152
    s_lshl_b32 s87, s93, 10
    s_add_u32 s87, s87, s95
    s_add_u32 s93, s93, 1
    s_and_b32 s93, s93, 15
    buffer_load_dwordx4 v[64:67], v232, s[64:67], s87 offen sc1
    v_mfma_f32_16x16x32_bf16 v[96:99], v[128:131], v[44:47], v[96:99]
    ds_read_b64_tr_b16 v[114:115], v228 offset:51200
    v_mfma_f32_16x16x32_bf16 v[84:87], v[132:135], v[40:43], v[84:87]
    ds_read_b64_tr_b16 v[116:117], v229 offset:49152
    v_mfma_f32_16x16x32_bf16 v[100:103], v[132:135], v[44:47], v[100:103]
    ds_read_b64_tr_b16 v[118:119], v229 offset:51200
    buffer_load_dwordx4 v[68:71], v233, s[64:67], s87 offen sc1
    v_mfma_f32_16x16x32_bf16 v[88:91], v[136:139], v[40:43], v[88:91]
    ds_read_b64_tr_b16 v[120:121], v230 offset:49152
    v_mfma_f32_16x16x32_bf16 v[104:107], v[136:139], v[44:47], v[104:107]
    ds_read_b64_tr_b16 v[122:123], v230 offset:51200
    v_mfma_f32_16x16x32_bf16 v[92:95], v[140:143], v[40:43], v[92:95]
    ds_read_b64_tr_b16 v[124:125], v231 offset:49152
    v_mfma_f32_16x16x32_bf16 v[108:111], v[140:143], v[44:47], v[108:111]
    ds_read_b64_tr_b16 v[126:127], v231 offset:51200
    s_waitcnt vmcnt(4) lgkmcnt(0)
    v_mfma_f32_16x16x32_bf16 v[80:83], v[112:115], v[48:51], v[80:83]
    ds_read_b64_tr_b16 v[128:129], v228 offset:53248
    s_lshl_b32 s87, s93, 10
    s_add_u32 s87, s87, s95
    s_add_u32 s93, s93, 1
    s_and_b32 s93, s93, 15
    buffer_load_dwordx4 v[72:75], v232, s[64:67], s87 offen sc1
    v_mfma_f32_16x16x32_bf16 v[96:99], v[112:115], v[52:55], v[96:99]
    ds_read_b64_tr_b16 v[130:131], v228 offset:55296
    v_mfma_f32_16x16x32_bf16 v[84:87], v[116:119], v[48:51], v[84:87]
    ds_read_b64_tr_b16 v[132:133], v229 offset:53248
    v_mfma_f32_16x16x32_bf16 v[100:103], v[116:119], v[52:55], v[100:103]
    ds_read_b64_tr_b16 v[134:135], v229 offset:55296
    buffer_load_dwordx4 v[76:79], v233, s[64:67], s87 offen sc1
    v_mfma_f32_16x16x32_bf16 v[88:91], v[120:123], v[48:51], v[88:91]
    ds_read_b64_tr_b16 v[136:137], v230 offset:53248
    v_mfma_f32_16x16x32_bf16 v[104:107], v[120:123], v[52:55], v[104:107]
    ds_read_b64_tr_b16 v[138:139], v230 offset:55296
    v_mfma_f32_16x16x32_bf16 v[92:95], v[124:127], v[48:51], v[92:95]
    ds_read_b64_tr_b16 v[140:141], v231 offset:53248
    v_mfma_f32_16x16x32_bf16 v[108:111], v[124:127], v[52:55], v[108:111]
    ds_read_b64_tr_b16 v[142:143], v231 offset:55296
    buffer_store_dwordx4 v[176:179], v185, s[60:63], 0 offen nt
    s_waitcnt vmcnt(5) lgkmcnt(0)
    v_mfma_f32_16x16x32_bf16 v[80:83], v[128:131], v[56:59], v[80:83]
    ds_read_b64_tr_b16 v[112:113], v228 offset:57344
    v_mfma_f32_16x16x32_bf16 v[96:99], v[128:131], v[60:63], v[96:99]
    ds_read_b64_tr_b16 v[114:115], v228 offset:59392
    v_mfma_f32_16x16x32_bf16 v[84:87], v[132:135], v[56:59], v[84:87]
    ds_read_b64_tr_b16 v[116:117], v229 offset:57344
    v_mfma_f32_16x16x32_bf16 v[100:103], v[132:135], v[60:63], v[100:103]
    ds_read_b64_tr_b16 v[118:119], v229 offset:59392
    v_mfma_f32_16x16x32_bf16 v[88:91], v[136:139], v[56:59], v[88:91]
    ds_read_b64_tr_b16 v[120:121], v230 offset:57344
    v_mfma_f32_16x16x32_bf16 v[104:107], v[136:139], v[60:63], v[104:107]
    ds_read_b64_tr_b16 v[122:123], v230 offset:59392
    v_mfma_f32_16x16x32_bf16 v[92:95], v[140:143], v[56:59], v[92:95]
    ds_read_b64_tr_b16 v[124:125], v231 offset:57344
    v_mfma_f32_16x16x32_bf16 v[108:111], v[140:143], v[60:63], v[108:111]
    ds_read_b64_tr_b16 v[126:127], v231 offset:59392
    s_waitcnt vmcnt(3) lgkmcnt(0)
    v_mfma_f32_16x16x32_bf16 v[80:83], v[112:115], v[64:67], v[80:83]
    ds_read_b64_tr_b16 v[128:129], v228 offset:61440
    v_mfma_f32_16x16x32_bf16 v[96:99], v[112:115], v[68:71], v[96:99]
    ds_read_b64_tr_b16 v[130:131], v228 offset:63488
    v_mfma_f32_16x16x32_bf16 v[84:87], v[116:119], v[64:67], v[84:87]
    ds_read_b64_tr_b16 v[132:133], v229 offset:61440
    v_mfma_f32_16x16x32_bf16 v[100:103], v[116:119], v[68:71], v[100:103]
    ds_read_b64_tr_b16 v[134:135], v229 offset:63488
    v_mfma_f32_16x16x32_bf16 v[88:91], v[120:123], v[64:67], v[88:91]
    ds_read_b64_tr_b16 v[136:137], v230 offset:61440
    v_mfma_f32_16x16x32_bf16 v[104:107], v[120:123], v[68:71], v[104:107]
    ds_read_b64_tr_b16 v[138:139], v230 offset:63488
    v_mfma_f32_16x16x32_bf16 v[92:95], v[124:127], v[64:67], v[92:95]
    ds_read_b64_tr_b16 v[140:141], v231 offset:61440
    v_mfma_f32_16x16x32_bf16 v[108:111], v[124:127], v[68:71], v[108:111]
    ds_read_b64_tr_b16 v[142:143], v231 offset:63488
    buffer_store_dwordx4 v[180:183], v184, s[60:63], 0 offen nt
    s_waitcnt vmcnt(2) lgkmcnt(0)
    v_mfma_f32_16x16x32_bf16 v[80:83], v[128:131], v[72:75], v[80:83]
    ds_read_b32 v6, v12
    v_mfma_f32_16x16x32_bf16 v[96:99], v[128:131], v[76:79], v[96:99]
    ds_read_b128 v[192:195], v10 offset:0
    v_mfma_f32_16x16x32_bf16 v[84:87], v[132:135], v[72:75], v[84:87]
    ds_read_b128 v[196:199], v10 offset:1024
    v_mfma_f32_16x16x32_bf16 v[100:103], v[132:135], v[76:79], v[100:103]
    ds_read_b128 v[200:203], v10 offset:2048
    v_mfma_f32_16x16x32_bf16 v[88:91], v[136:139], v[72:75], v[88:91]
    ds_read_b128 v[204:207], v10 offset:3072
    v_mfma_f32_16x16x32_bf16 v[104:107], v[136:139], v[76:79], v[104:107]
    ds_read_b128 v[208:211], v11 offset:0
    v_mfma_f32_16x16x32_bf16 v[92:95], v[140:143], v[72:75], v[92:95]
    ds_read_b128 v[212:215], v11 offset:1024
    v_mfma_f32_16x16x32_bf16 v[108:111], v[140:143], v[76:79], v[108:111]
    ds_read_b128 v[216:219], v11 offset:2048
    ds_read_b128 v[220:223], v11 offset:3072
    s_branch tk_30_c
tk_30:
    ds_read_b32 v6, v12
    ds_read_b128 v[192:195], v10 offset:0
    ds_read_b128 v[196:199], v10 offset:1024
    ds_read_b128 v[200:203], v10 offset:2048
    ds_read_b128 v[204:207], v10 offset:3072
    ds_read_b128 v[208:211], v11 offset:0
    ds_read_b128 v[212:215], v11 offset:1024
    ds_read_b128 v[216:219], v11 offset:2048
    ds_read_b128 v[220:223], v11 offset:3072
tk_30_c:
    s_waitcnt lgkmcnt(0)
    v_readfirstlane_b32 s81, v6
    s_nop 1
    s_cmp_eq_u32 s81, 0
    s_cbranch_scc1 tk_30
    v_pk_add_f32 v[192:193], v[192:193], v[80:81]
    v_pk_add_f32 v[194:195], v[194:195], v[82:83]
    v_pk_add_f32 v[196:197], v[196:197], v[84:85]
    v_pk_add_f32 v[198:199], v[198:199], v[86:87]
    v_pk_add_f32 v[200:201], v[200:201], v[88:89]
    v_pk_add_f32 v[202:203], v[202:203], v[90:91]
    v_pk_add_f32 v[204:205], v[204:205], v[92:93]
    v_pk_add_f32 v[206:207], v[206:207], v[94:95]
    v_cvt_pk_bf16_f32 v16, v192, v193
    v_cvt_pk_bf16_f32 v17, v194, v195
    v_cvt_pk_bf16_f32 v18, v196, v197
    v_cvt_pk_bf16_f32 v19, v198, v199
    v_cvt_pk_bf16_f32 v20, v200, v201
    v_cvt_pk_bf16_f32 v21, v202, v203
    v_cvt_pk_bf16_f32 v22, v204, v205
    v_cvt_pk_bf16_f32 v23, v206, v207
    v_permlane16_swap_b32 v16, v18
    v_permlane16_swap_b32 v17, v19
    v_permlane16_swap_b32 v20, v22
    v_permlane16_swap_b32 v21, v23
    buffer_store_dwordx4 v[16:19], v13, s[60:63], 0 offen offset:0 nt
    buffer_store_dwordx4 v[20:23], v13, s[60:63], 0 offen offset:64 nt
    v_pk_add_f32 v[208:209], v[208:209], v[96:97]
    v_pk_add_f32 v[210:211], v[210:211], v[98:99]
    v_pk_add_f32 v[212:213], v[212:213], v[100:101]
    v_pk_add_f32 v[214:215], v[214:215], v[102:103]
    v_pk_add_f32 v[216:217], v[216:217], v[104:105]
    v_pk_add_f32 v[218:219], v[218:219], v[106:107]
    v_pk_add_f32 v[220:221], v[220:221], v[108:109]
    v_pk_add_f32 v[222:223], v[222:223], v[110:111]
    v_cvt_pk_bf16_f32 v24, v208, v209
    v_cvt_pk_bf16_f32 v25, v210, v211
    v_cvt_pk_bf16_f32 v26, v212, v213
    v_cvt_pk_bf16_f32 v27, v214, v215
    v_cvt_pk_bf16_f32 v28, v216, v217
    v_cvt_pk_bf16_f32 v29, v218, v219
    v_cvt_pk_bf16_f32 v30, v220, v221
    v_cvt_pk_bf16_f32 v31, v222, v223
    v_permlane16_swap_b32 v24, v26
    v_permlane16_swap_b32 v25, v27
    v_permlane16_swap_b32 v28, v30
    v_permlane16_swap_b32 v29, v31
    buffer_store_dwordx4 v[24:27], v14, s[60:63], 0 offen offset:0 nt
    buffer_store_dwordx4 v[28:31], v14, s[60:63], 0 offen offset:64 nt
L_out:
L_end:
    s_endpgm
.section .rodata,"a"
.p2align 6
.amdhsa_kernel concat_heads__sliding_local_dilated__spectral_fnet__prompt_kernel
  .amdhsa_next_free_vgpr 256
  .amdhsa_next_free_sgpr 102
  .amdhsa_accum_offset 256
  .amdhsa_group_segment_fixed_size 0
  .amdhsa_kernarg_size 88
  .amdhsa_user_sgpr_count 2
  .amdhsa_user_sgpr_kernarg_segment_ptr 1
  .amdhsa_system_sgpr_workgroup_id_x 1
  .amdhsa_float_denorm_mode_32 3
.end_amdhsa_kernel
```
